```python
import torch

def _softmax(x, axis=-1):
    return torch.softmax(x, dim=axis)
def _gelu(x):
    return torch.nn.functional.gelu(x, approximate="tanh")
def _silu(x):
    return torch.nn.functional.silu(x)
def _sigmoid(x):
    return torch.sigmoid(x)
def _layernorm(x, axis=-1, eps=1e-5):
    m = x.mean(dim=axis, keepdim=True)
    v = x.var(dim=axis, keepdim=True, unbiased=False)
    return (x - m) / torch.sqrt(v + eps)
def _scatter_add(tgt, idx, src, axis=0):
    return tgt.clone().index_add_(axis, idx, src)
def _segment_sum(src, seg, n):
    out = torch.zeros((n,) + src.shape[1:], dtype=src.dtype)
    return out.index_add_(0, seg, src)
def _pad(x, pw):
    flat = tuple(v for pair in reversed(pw) for v in pair)
    return torch.nn.functional.pad(x, flat)

kernel_name = 'standalone__edge_featured_mpnn_mpnn__graph'

def setup_inputs():

    _w = (lambda a: (lambda t: t.to(torch.bfloat16) if t.is_floating_point() else t)(torch.as_tensor(a)))
    N, deg, D, De = 10000, 64, 64, max(16, 1)
    E = N * deg
    H = 2 * D
    return {
        "x": _w((lambda *s: torch.randn(*s, dtype=torch.bfloat16) * 0.05)(N, D)),
        "e_attr": _w((lambda *s: torch.randn(*s, dtype=torch.bfloat16) * 0.8)(E, De)),
        "src": _w((lambda lo, hi, *s: torch.randint(lo, hi, s))(0, N, E).to(torch.int64)),
        "dst": _w((lambda lo, hi, *s: torch.randint(lo, hi, s))(0, N, E).to(torch.int64)),
        "w1": _w((lambda *s: torch.randn(*s, dtype=torch.bfloat16) * 0.8)(2 * D + De, H) * (1.0 / (2 * D + De) ** 0.5)),
        "b1": _w((lambda *s: torch.randn(*s, dtype=torch.bfloat16) * 0.4)(H) * 0.01),
        "w2": _w((lambda *s: torch.randn(*s, dtype=torch.bfloat16) * 0.05)(H, D) * (1.0 / H ** 0.5)),
        "b2": _w((lambda *s: torch.randn(*s, dtype=torch.bfloat16) * 0.05)(D) * 0.01),
    }

def reference(x, e_attr, src, dst, w1, b1, w2, b2):
    N, D = x.shape
    h_src = x[src]
    h_dst = x[dst]
    m_in = torch.concatenate([h_src, h_dst, e_attr], axis=-1)
    h = _silu(m_in @ w1 + b1)
    msg = h @ w2 + b2
    return _segment_sum(msg, dst, N)
```

```asm
; @launch grid=(256,1,1) block=(512,1,1) lds=161664
.amdgcn_target "amdgcn-amd-amdhsa--gfx950"
.text
.globl standalone__edge_featured_mpnn_mpnn__graph_kernel
.p2align 8
.type standalone__edge_featured_mpnn_mpnn__graph_kernel,@function
standalone__edge_featured_mpnn_mpnn__graph_kernel:
    s_cmp_ge_u32 s2, 256
    s_cbranch_scc1 K_END
    s_load_dwordx16 s[36:51], s[0:1], 0
    s_load_dwordx4 s[52:55], s[0:1], 64
    s_load_dwordx2 s[12:13], s[0:1], 80
    v_lshrrev_b32 v2, 6, v0
    v_and_b32 v1, 63, v0
    v_lshlrev_b32 v3, 4, v0
    v_readfirstlane_b32 s24, v2
    s_getpc_b64 s[58:59]
    s_bfe_u32 s3, s2, 0x20003
    s_mul_i32 s3, s3, 6144
    v_lshl_add_u32 v4, v0, 7, s3
    v_cmp_gt_u32 vcc, 48, v0
    s_mov_b64 exec, vcc
    global_load_dword v131, v4, s[58:59]
    s_mov_b64 exec, -1
    v_lshlrev_b32 v10, 2, v0
    v_add_u32 v5, 8000, v10
    v_mov_b32 v2, 0
    v_add_u32 v6, 157568, v10
    ds_write_b32 v6, v3
    ds_write_b32 v10, v2 offset:512
    v_cmp_gt_u32 vcc, 500, v0
    s_mov_b64 s[22:23], vcc
    s_mul_i32 s3, s2, 10000
    s_mov_b64 exec, s[22:23]
    s_waitcnt lgkmcnt(0)
    s_add_u32 s42, s42, s3
    s_addc_u32 s43, s43, 0
    s_add_u32 s40, s40, s3
    s_addc_u32 s41, s41, 0
    global_load_dwordx4 v[16:19], v3, s[42:43]
    global_load_dword v20, v5, s[42:43]
    global_load_dwordx4 v[24:27], v3, s[40:41]
    global_load_dword v28, v5, s[40:41]
    s_mov_b64 exec, -1
    v_lshlrev_b32 v6, 21, v1
    s_cmp_eq_u32 s24, 6
    s_cselect_b64 exec, 31, 0
    global_load_dword v131, v6, s[12:13]
    s_cselect_b64 exec, 1, 0
    global_load_dword v131, v6, s[52:53]
    global_load_dword v131, v6, s[48:49]
    global_load_dword v131, v6, s[50:51]
    s_cselect_b32 exec_lo, 0x3ff, 0
    global_load_dword v131, v6, s[38:39]
    s_mov_b64 exec, -1
    s_mov_b32 s20, s54
    s_mov_b32 s21, s55
    s_or_b32 s30, s2, s24
    s_cbranch_scc1 K_notag
    s_memrealtime s[58:59]
    s_waitcnt lgkmcnt(0)
    s_or_b32 s58, s58, 1
    v_mov_b32 v66, s58
    v_mov_b32 v67, s59
    v_mov_b32 v68, 0
    v_mov_b32 v69, 0
    s_mov_b64 exec, 1
    global_atomic_cmpswap_x2 v2, v[66:69], s[20:21]
    s_mov_b64 exec, -1
K_notag:
    s_and_b32 s73, s2, 7
    s_lshl_b32 s73, s73, 5
    s_lshr_b32 s30, s2, 3
    s_or_b32 s73, s73, s30
    v_lshlrev_b32 v13, 4, v1
    v_lshrrev_b32 v155, 5, v1
    v_lshlrev_b32 v155, 4, v155
    s_mul_i32 s27, s24, 10240
    s_add_u32 s27, s27, 79744
    v_lshrrev_b32 v157, 4, v1
    v_and_b32 v159, 7, v1
    v_xor_b32 v159, v159, v157
    v_lshlrev_b32 v159, 4, v159
    v_xor_b32 v139, 64, v159
    v_or_b32 v137, 0x400, v159
    v_or_b32 v135, 0x800, v139
    v_or_b32 v133, 0xc00, v159
    v_xor_b32 v159, v1, v157
    v_and_b32 v159, 1, v159
    v_lshlrev_b32 v141, 4, v159
    v_lshrrev_b32 v157, 5, v1
    v_and_b32 v158, 31, v1
    v_lshlrev_b32 v156, 2, v158
    v_add_u32 v156, 27904, v156
    v_bfe_u32 v159, v1, 1, 3
    v_xor_b32 v159, v159, v157
    v_lshlrev_b32 v154, 7, v158
    v_add_u32 v154, s27, v154
    v_xor_b32 v150, 0, v159
    v_lshl_add_u32 v150, v150, 4, v154
    v_xor_b32 v151, 2, v159
    v_lshl_add_u32 v151, v151, 4, v154
    v_xor_b32 v152, 4, v159
    v_lshl_add_u32 v152, v152, 4, v154
    v_xor_b32 v153, 6, v159
    v_lshl_add_u32 v153, v153, 4, v154
    v_bfe_u32 v159, v1, 3, 1
    v_xor_b32 v159, v159, v157
    v_lshlrev_b32 v159, 4, v159
    v_lshl_add_u32 v154, v158, 5, v159
    s_add_u32 s30, s27, 4096
    v_add_u32 v154, s30, v154
    s_lshl_b32 s56, s24, 10
    s_lshl_b32 s30, s24, 11
    s_add_u32 s30, s30, s73
    v_lshrrev_b32 v8, 3, v1
    v_lshl_add_u32 v8, v8, 8, s30
    s_and_b32 s30, s24, 1
    s_lshl_b32 s30, s30, 6
    v_xor_b32 v9, s30, v133
    v_lshrrev_b32 v129, 4, v1
    v_lshlrev_b32 v129, 3, v129
    s_and_b32 s30, s24, 3
    s_lshl_b32 s30, s30, 6
    v_and_b32 v11, 31, v1
    v_lshl_add_u32 v11, v11, 1, s30
    v_lshrrev_b32 v64, 4, v1
    v_lshlrev_b32 v64, 6, v64
    v_xor_b32 v64, v64, v13
    s_barrier
    s_mov_b32 s76, s44
    s_mov_b32 s77, s45
    s_mov_b32 s78, 36864
    s_mov_b32 s79, 0x20000
    s_nop 0
    s_sub_u32 s4, s36, 3072
    s_subb_u32 s5, s37, 0
    s_and_b32 s5, s5, 0xffff
    s_or_b32 s5, s5, 8388608
    s_mov_b32 s6, 10000
    s_mov_b32 s7, 0x20000
    global_load_ushort v128, v11, s[46:47]
    s_mov_b32 s61, 0x80
    v_mov_b32 v4, 0x0800ffff
    v_mov_b32 v5, -1
    v_mov_b32 v6, v4
    v_mov_b32 v7, -1
    ds_write_b128 v3, v[4:7] offset:3200
    ds_write_b128 v3, v[4:7] offset:11392
    ds_write_b128 v3, v[4:7] offset:19584
    v_bfe_u32 v5, v0, 4, 3
    v_and_b32 v6, 7, v0
    v_cmp_eq_u32 vcc, v5, v6
    v_bfe_u32 v5, v0, 4, 2
    v_and_b32 v7, 1, v0
    v_bfe_u32 v6, v0, 2, 1
    v_lshl_or_b32 v6, v6, 1, v7
    v_and_b32 v7, 2, v0
    v_lshl_or_b32 v6, v7, 4, v6
    v_cmp_eq_u32 s[32:33], v5, v6
    v_cmp_gt_u32 s[34:35], s61, v0
    v_bfe_u32 v5, v0, 3, 1
    v_lshlrev_b32 v5, 4, v5
    v_mov_b32 v6, 0x3f80
    v_lshlrev_b32 v5, v5, v6
    s_and_b64 vcc, vcc, s[34:35]
    s_andn2_b64 s[32:33], s[32:33], s[34:35]
    s_or_b64 vcc, vcc, s[32:33]
    v_add_u32 v7, 512, v10
    v_cndmask_b32 v5, 0, v5, vcc
    v_cndmask_b32 v6, v7, v10, s[34:35]
    v_cmp_gt_u32 vcc, 0x100, v0
    v_and_b32 v7, 28, v10
    v_add_u32 v7, 0xc00, v7
    v_mov_b32 v4, 4
    v_cndmask_b32 v6, v7, v6, vcc
    v_cndmask_b32 v5, 0, v5, vcc
    ds_write_b32 v6, v5
    v_and_b32 v158, 31, v1
    v_lshrrev_b32 v157, 2, v158
    v_and_b32 v157, 4, v157
    v_lshrrev_b32 v159, 1, v158
    v_and_b32 v159, 2, v159
    v_and_b32 v149, 1, v158
    v_or3_b32 v149, v149, v157, v159
    v_lshlrev_b32 v157, 1, v158
    v_and_b32 v157, 16, v157
    v_lshlrev_b32 v159, 2, v158
    v_and_or_b32 v142, v159, 8, v157
    v_lshrrev_b32 v158, 1, v1
    v_lshrrev_b32 v157, 2, v158
    v_and_b32 v157, 4, v157
    v_lshrrev_b32 v159, 1, v158
    v_and_b32 v159, 2, v159
    v_and_b32 v148, 1, v158
    v_or3_b32 v148, v148, v157, v159
    v_lshlrev_b32 v157, 1, v158
    v_and_b32 v157, 16, v157
    v_lshlrev_b32 v159, 2, v158
    global_load_dwordx2 v[66:67], v2, s[20:21] sc1
    v_and_or_b32 v140, v159, 8, v157
    v_lshrrev_b32 v158, 3, v1
    v_lshrrev_b32 v157, 2, v158
    v_and_b32 v157, 4, v157
    v_lshrrev_b32 v159, 1, v158
    v_and_b32 v159, 2, v159
    v_and_b32 v146, 1, v158
    v_or3_b32 v146, v146, v157, v159
    v_lshlrev_b32 v157, 1, v158
    v_and_b32 v157, 16, v157
    v_lshlrev_b32 v159, 2, v158
    v_and_or_b32 v147, v159, 8, v157
    s_mov_b32 s80, s48
    s_mov_b32 s81, s49
    s_mov_b32 s82, 16384
    s_mov_b32 s83, 0x20000
    s_mov_b32 s96, s50
    s_mov_b32 s97, s51
    s_mov_b32 s8, s38
    s_and_b32 s9, s39, 0xffff
    s_or_b32 s9, s9, 2097152
    s_mov_b32 s10, 640000
    s_mov_b32 s11, 0x20000
    s_mov_b32 s14, 0x1000000
    s_mov_b32 s15, 0x20000
    s_mov_b32 s16, s52
    s_mov_b32 s17, s53
    s_mov_b32 s18, 1280000
    s_mov_b32 s19, 0x20000
    s_mov_b32 s64, 0x9e0
    s_mov_b32 s66, -1
    s_mov_b32 s67, 0
    s_mov_b32 s68, 0
    s_mov_b32 s69, -1
    s_lshl_b32 s84, s73, 6
    s_add_u32 s85, s84, 2097152
    s_add_u32 s86, s84, 4194304
    s_add_u32 s87, s85, 4194304
    s_mov_b32 s58, 157568
    s_mov_b32 s59, 124800
    s_mov_b32 s60, 127
    v_mov_b32 v164, 0
    v_mov_b32 v165, 0
    v_lshrrev_b32 v48, 2, v0
    v_and_b32 v49, 3, v0
    v_lshlrev_b32 v50, 7, v48
    v_add_u32 v49, v49, v48
    v_and_b32 v52, 7, v49
    v_xor_b32 v53, 4, v52
    v_add_u32 v50, 124800, v50
    v_lshl_add_u32 v52, v52, 4, v50
    v_lshl_add_u32 v53, v53, 4, v50
    v_and_b32 v48, 0xfe, v48
    v_lshlrev_b32 v54, 2, v48
    v_add_u32 v54, 157568, v54
    v_add_u32 v12, 157568, v13
    v_lshl_add_u32 v55, v48, 4, 64
    s_lshl_b32 s62, s2, 10
    s_add_u32 s62, s62, 8388608
    s_cmp_eq_u32 s24, 7
    s_cselect_b64 exec, -1, 0
    buffer_store_dwordx4 v[48:51], v13, s[12:15], s62 offen sc1
    s_mov_b64 exec, -1
    s_mov_b64 exec, s[22:23]
    s_waitcnt vmcnt(11)
    v_and_b32 v56, 0xff, v16
    v_lshl_add_u32 v32, v56, 2, s58
    ds_add_rtn_u32 v40, v32, v4
    v_and_b32 v57, 0xff, v17
    v_lshl_add_u32 v33, v57, 2, s58
    ds_add_rtn_u32 v41, v33, v4
    v_and_b32 v58, 0xff, v18
    v_lshl_add_u32 v34, v58, 2, s58
    ds_add_rtn_u32 v42, v34, v4
    v_and_b32 v59, 0xff, v19
    v_lshl_add_u32 v35, v59, 2, s58
    ds_add_rtn_u32 v43, v35, v4
    s_waitcnt vmcnt(10)
    v_and_b32 v60, 0xff, v20
    v_lshl_add_u32 v36, v60, 2, s58
    ds_add_rtn_u32 v44, v36, v4
    s_mov_b64 exec, -1
    s_add_u32 m0, s56, 116608
    s_mov_b32 s57, s56
    buffer_load_dwordx4 v[8:9], s[4:7], 0 idxen offen lds
    s_add_u32 m0, s57, 79744
    s_nop 0
    buffer_load_dwordx4 v64, s[76:79], s57 offen lds
    s_add_u32 s57, s57, 0x2000
    s_add_u32 m0, s57, 79744
    s_nop 0
    buffer_load_dwordx4 v64, s[76:79], s57 offen lds
    s_add_u32 s57, s57, 0x2000
    s_add_u32 m0, s57, 79744
    s_nop 0
    buffer_load_dwordx4 v64, s[76:79], s57 offen lds
    s_add_u32 s57, s57, 0x2000
    s_add_u32 m0, s57, 79744
    s_nop 0
    buffer_load_dwordx4 v64, s[76:79], s57 offen lds
    s_add_u32 s57, s57, 0x2000
    s_add_u32 m0, s57, 79744
    s_cmp_ge_u32 s24, 4
    s_cselect_b32 m0, 159616, m0
    s_nop 0
    buffer_load_dwordx4 v64, s[76:79], s57 offen lds
    s_mov_b64 exec, s[22:23]
    v_lshl_add_u32 v56, v56, 7, s59
    v_lshrrev_b32 v16, 8, v16
    v_lshl_add_u32 v57, v57, 7, s59
    v_lshrrev_b32 v17, 8, v17
    v_lshl_add_u32 v58, v58, 7, s59
    v_lshrrev_b32 v18, 8, v18
    v_lshl_add_u32 v59, v59, 7, s59
    v_lshrrev_b32 v19, 8, v19
    v_lshl_add_u32 v60, v60, 7, s59
    v_lshrrev_b32 v20, 8, v20
    s_waitcnt vmcnt(14)
    v_lshl_or_b32 v24, v16, 26, v24
    v_add_u32 v16, 0, v10
    v_lshl_or_b32 v24, v16, 14, v24
    v_lshl_or_b32 v25, v17, 26, v25
    v_add_u32 v17, 1, v10
    v_lshl_or_b32 v25, v17, 14, v25
    v_lshl_or_b32 v26, v18, 26, v26
    v_add_u32 v18, 2, v10
    v_lshl_or_b32 v26, v18, 14, v26
    v_lshl_or_b32 v27, v19, 26, v27
    v_add_u32 v19, 3, v10
    v_lshl_or_b32 v27, v19, 14, v27
    v_lshl_or_b32 v28, v20, 26, v28
    v_add_u32 v20, 2000, v0
    v_lshl_or_b32 v28, v20, 14, v28
    s_waitcnt lgkmcnt(4)
    v_and_or_b32 v56, v40, s60, v56
    ds_write_b32 v56, v24
    s_waitcnt lgkmcnt(4)
    v_and_or_b32 v57, v41, s60, v57
    ds_write_b32 v57, v25
    s_waitcnt lgkmcnt(4)
    v_and_or_b32 v58, v42, s60, v58
    ds_write_b32 v58, v26
    s_waitcnt lgkmcnt(4)
    v_and_or_b32 v59, v43, s60, v59
    ds_write_b32 v59, v27
    s_waitcnt lgkmcnt(4)
    v_and_or_b32 v60, v44, s60, v60
    ds_write_b32 v60, v28
    s_mov_b64 exec, -1
    s_lshl_b32 s3, s2, 14
    s_add_u32 s57, s3, 8192
    s_add_u32 s62, s3, 4194304
    s_add_u32 s63, s57, 4194304
    s_waitcnt lgkmcnt(0)
    s_barrier
    ds_read_b128 v[68:71], v52
    ds_read_b128 v[72:75], v52 offset:16384
    ds_read_b64 v[76:77], v54
    ds_read_b64 v[78:79], v54 offset:512
    ds_read_b128 v[80:83], v53
    ds_read_b128 v[84:87], v53 offset:16384
    ds_read_b128 v[56:59], v12
    s_waitcnt lgkmcnt(6)
    buffer_store_dwordx4 v[68:71], v3, s[12:15], s3 offen sc1
    s_waitcnt lgkmcnt(5)
    buffer_store_dwordx4 v[72:75], v3, s[12:15], s57 offen sc1
    s_waitcnt lgkmcnt(3)
    v_subrev_u32 v77, 16, v77
    v_subrev_u32 v79, 16, v79
    v_max_u32 v76, v76, v77
    v_max_u32 v78, v78, v79
    v_cmp_gt_u32 vcc, v76, v55
    v_add_u32 v55, 2048, v55
    v_cmp_gt_u32 s[32:33], v78, v55
    s_waitcnt lgkmcnt(1)
    s_mov_b64 exec, vcc
    buffer_store_dwordx4 v[80:83], v3, s[12:15], s62 offen sc1
    s_mov_b64 exec, s[32:33]
    buffer_store_dwordx4 v[84:87], v3, s[12:15], s63 offen sc1
    s_mov_b64 exec, -1
    v_lshlrev_b32 v4, 2, v13
    s_waitcnt lgkmcnt(0)
    v_sub_u32 v56, v56, v4
    v_lshrrev_b32 v56, 2, v56
    v_min_u32 v56, 0xff, v56
    v_sub_u32 v57, v57, v4
    v_subrev_u32 v57, 16, v57
    v_lshrrev_b32 v57, 2, v57
    v_min_u32 v57, 0xff, v57
    v_sub_u32 v58, v58, v4
    v_subrev_u32 v58, 32, v58
    v_lshrrev_b32 v58, 2, v58
    v_min_u32 v58, 0xff, v58
    v_sub_u32 v59, v59, v4
    v_subrev_u32 v59, 48, v59
    v_lshrrev_b32 v59, 2, v59
    v_min_u32 v59, 0xff, v59
    v_lshl_or_b32 v63, v57, 8, v56
    v_lshl_or_b32 v63, v58, 16, v63
    v_lshl_or_b32 v63, v59, 24, v63
    v_bfe_u32 v6, v1, 2, 2
    v_lshrrev_b32 v5, 1, v155
    v_add_u32 v4, v6, v5
    v_lshlrev_b32 v4, 8, v4
    v_bfe_u32 v5, v1, 4, 1
    v_lshl_add_u32 v4, v5, 5, v4
    v_and_b32 v5, 3, v1
    v_lshl_add_u32 v4, v5, 3, v4
    s_and_b32 s30, s24, 3
    v_xor_b32 v6, s30, v6
    v_lshl_add_u32 v4, v6, 6, v4
    v_add_u32 v6, 79744, v4
    s_lshr_b32 s61, s24, 2
    s_lshl_b32 s30, s61, 12
    v_add_u32 v7, s30, v6
    s_add_u32 s30, s30, 116608
    s_sub_u32 s30, s30, s27
    v_add_u32 v76, s30, v150
    v_add_u32 v77, s30, v151
    v_add_u32 v78, s30, v152
    v_add_u32 v79, s30, v153
    v_lshrrev_b32 v11, 2, v0
    v_and_b32 v12, 1, v0
    v_lshl_add_u32 v12, v12, 7, v11
    v_lshlrev_b32 v9, 10, v12
    v_and_b32 v12, 3, v0
    v_lshlrev_b32 v12, 4, v12
    v_lshl_add_u32 v12, v11, 14, v12
    v_mul_u32_u24 v11, 2500, v11
    s_lshl_b32 s56, s2, 10
    s_add_u32 s56, s56, 8388608
    s_lshr_b32 s57, s73, 2
    s_lshl_b32 s57, s57, 4
    s_add_u32 s57, s57, 8388608
    s_mov_b32 s58, 3216550459
    s_mov_b32 s59, s58
    s_mov_b32 s26, 0
    s_waitcnt vmcnt(0)
K_tagpoll:
    v_readfirstlane_b32 s28, v66
    v_readfirstlane_b32 s29, v67
    s_cmp_lg_u32 s28, 0
    s_cbranch_scc1 K_tagok
    global_load_dwordx2 v[66:67], v2, s[20:21] sc1
    s_add_u32 s26, s26, 1
    s_cmp_lt_u32 s26, 0x200000
    s_waitcnt vmcnt(0)
    s_cbranch_scc1 K_tagpoll
K_tagok:
    v_mov_b32 v60, v66
    v_mov_b32 v61, v67
    v_mov_b32 v62, v66
    s_barrier
    s_cmp_eq_u32 s24, 0
    s_cselect_b64 exec, -1, 0
    buffer_store_dwordx4 v[60:63], v13, s[12:15], s56 offen sc1
    s_mov_b64 exec, -1
    ds_read_b64_tr_b16 v[16:17], v7 offset:0
    ds_read_b64_tr_b16 v[18:19], v7 offset:1024
    ds_read_b64_tr_b16 v[20:21], v7 offset:8192
    ds_read_b64_tr_b16 v[22:23], v7 offset:9216
    ds_read_b64_tr_b16 v[24:25], v6 offset:32768
    ds_read_b64_tr_b16 v[26:27], v6 offset:33792
    ds_read_b64_tr_b16 v[96:97], v6 offset:16384
    ds_read_b64_tr_b16 v[98:99], v6 offset:17408
    ds_read_b64_tr_b16 v[100:101], v6 offset:20480
    ds_read_b64_tr_b16 v[102:103], v6 offset:21504
    ds_read_b64_tr_b16 v[104:105], v6 offset:24576
    ds_read_b64_tr_b16 v[106:107], v6 offset:25600
    ds_read_b64_tr_b16 v[108:109], v6 offset:28672
    ds_read_b64_tr_b16 v[110:111], v6 offset:29696
    ds_read_b128 v[80:83], v76
    ds_read_b128 v[84:87], v77
    ds_read_b128 v[88:91], v78
    ds_read_b128 v[92:95], v79
    v_lshlrev_b32 v128, 16, v128
    v_mul_f32 v128, s58, v128
    s_lshl_b32 s30, s24, 10
    v_add_u32 v8, s30, v13
    s_and_b32 s30, s30, 0xfff
    v_add_u32 v7, s30, v13
    s_waitcnt lgkmcnt(12)
    v_lshlrev_b32 v32, 16, v16
    v_and_b32 v33, 0xffff0000, v16
    v_lshlrev_b32 v34, 16, v17
    v_and_b32 v35, 0xffff0000, v17
    v_lshlrev_b32 v36, 16, v18
    v_and_b32 v37, 0xffff0000, v18
    v_lshlrev_b32 v38, 16, v19
    v_and_b32 v39, 0xffff0000, v19
    v_lshlrev_b32 v40, 16, v20
    v_and_b32 v41, 0xffff0000, v20
    v_lshlrev_b32 v42, 16, v21
    v_and_b32 v43, 0xffff0000, v21
    v_lshlrev_b32 v44, 16, v22
    v_and_b32 v45, 0xffff0000, v22
    v_lshlrev_b32 v46, 16, v23
    v_and_b32 v47, 0xffff0000, v23
    v_lshlrev_b32 v48, 16, v24
    v_and_b32 v49, 0xffff0000, v24
    v_lshlrev_b32 v50, 16, v25
    v_and_b32 v51, 0xffff0000, v25
    v_lshlrev_b32 v52, 16, v26
    v_and_b32 v53, 0xffff0000, v26
    v_lshlrev_b32 v54, 16, v27
    v_and_b32 v55, 0xffff0000, v27
    v_pk_mul_f32 v[32:33], v[32:33], s[58:59]
    v_pk_mul_f32 v[34:35], v[34:35], s[58:59]
    v_pk_mul_f32 v[36:37], v[36:37], s[58:59]
    v_pk_mul_f32 v[38:39], v[38:39], s[58:59]
    v_pk_mul_f32 v[40:41], v[40:41], s[58:59]
    v_pk_mul_f32 v[42:43], v[42:43], s[58:59]
    v_pk_mul_f32 v[44:45], v[44:45], s[58:59]
    v_pk_mul_f32 v[46:47], v[46:47], s[58:59]
    v_pk_mul_f32 v[48:49], v[48:49], s[58:59]
    v_pk_mul_f32 v[50:51], v[50:51], s[58:59]
    v_pk_mul_f32 v[52:53], v[52:53], s[58:59]
    v_pk_mul_f32 v[54:55], v[54:55], s[58:59]
    s_waitcnt lgkmcnt(0)
    v_mfma_f32_32x32x16_bf16 v[112:127], v[80:83], v[96:99], 0
    v_cvt_pk_bf16_f32 v16, v32, v33
    v_cvt_pk_bf16_f32 v17, v34, v35
    v_cvt_pk_bf16_f32 v18, v36, v37
    v_mfma_f32_32x32x16_bf16 v[112:127], v[84:87], v[100:103], v[112:127]
    v_cvt_pk_bf16_f32 v19, v38, v39
    v_cvt_pk_bf16_f32 v20, v40, v41
    v_cvt_pk_bf16_f32 v21, v42, v43
    v_mfma_f32_32x32x16_bf16 v[112:127], v[88:91], v[104:107], v[112:127]
    v_cvt_pk_bf16_f32 v22, v44, v45
    v_cvt_pk_bf16_f32 v23, v46, v47
    v_cvt_pk_bf16_f32 v24, v48, v49
    v_mfma_f32_32x32x16_bf16 v[112:127], v[92:95], v[108:111], v[112:127]
    v_cvt_pk_bf16_f32 v25, v50, v51
    v_cvt_pk_bf16_f32 v26, v52, v53
    v_cvt_pk_bf16_f32 v27, v54, v55
    ds_write_b128 v8, v[16:19] offset:27904
    ds_write_b128 v8, v[20:23] offset:36096
    ds_write_b128 v7, v[24:27] offset:44288
    s_mov_b32 s26, 0
    s_and_b32 s60, s73, 3
    s_lshl_b32 s60, s60, 3
    s_and_b32 s30, s24, 3
    s_mul_i32 s30, s30, 3584
    s_lshr_b32 s31, s24, 2
    s_lshl_b32 s31, s31, 6
    s_add_u32 s30, s30, s31
    v_and_b32 v4, 31, v1
    v_mul_u32_u24 v4, 112, v4
    v_lshrrev_b32 v5, 1, v155
    v_add3_u32 v4, v4, v5, s30
    s_mov_b32 s3, 3216550459
    v_fma_f32 v112, v112, s3, v128
    v_fma_f32 v113, v113, s3, v128
    v_fma_f32 v114, v114, s3, v128
    v_fma_f32 v115, v115, s3, v128
    v_fma_f32 v116, v116, s3, v128
    v_fma_f32 v117, v117, s3, v128
    v_fma_f32 v118, v118, s3, v128
    v_fma_f32 v119, v119, s3, v128
    v_fma_f32 v120, v120, s3, v128
    v_fma_f32 v121, v121, s3, v128
    v_fma_f32 v122, v122, s3, v128
    v_fma_f32 v123, v123, s3, v128
    v_fma_f32 v124, v124, s3, v128
    v_fma_f32 v125, v125, s3, v128
    v_fma_f32 v126, v126, s3, v128
    v_fma_f32 v127, v127, s3, v128
    v_cvt_pk_bf16_f32 v96, v112, v113
    v_cvt_pk_bf16_f32 v97, v114, v115
    v_cvt_pk_bf16_f32 v98, v116, v117
    v_cvt_pk_bf16_f32 v99, v118, v119
    v_cvt_pk_bf16_f32 v100, v120, v121
    v_cvt_pk_bf16_f32 v101, v122, v123
    v_cvt_pk_bf16_f32 v102, v124, v125
    v_cvt_pk_bf16_f32 v103, v126, v127
    ds_write_b64 v4, v[96:97] offset:49024
    ds_write_b64 v4, v[98:99] offset:49040
    s_cmp_ge_u32 s24, 4
    s_cbranch_scc1 K_q48
    ds_write_b64 v4, v[100:101] offset:49056
    ds_write_b64 v4, v[102:103] offset:49072
K_q48:
    s_waitcnt lgkmcnt(0)
    s_barrier
    ds_read_b128 a[0:3], v13 offset:27904
    ds_read_b128 a[4:7], v13 offset:28928
    ds_read_b128 a[8:11], v13 offset:29952
    ds_read_b128 a[12:15], v13 offset:30976
    ds_read_b128 a[16:19], v13 offset:32000
    ds_read_b128 a[20:23], v13 offset:33024
    ds_read_b128 a[24:27], v13 offset:34048
    ds_read_b128 a[28:31], v13 offset:35072
    ds_read_b128 a[32:35], v13 offset:36096
    ds_read_b128 a[36:39], v13 offset:37120
    ds_read_b128 a[40:43], v13 offset:38144
    ds_read_b128 a[44:47], v13 offset:39168
    ds_read_b128 a[48:51], v13 offset:40192
    ds_read_b128 a[52:55], v13 offset:41216
    ds_read_b128 a[56:59], v13 offset:42240
    ds_read_b128 a[60:63], v13 offset:43264
    ds_read_b128 a[64:67], v13 offset:44288
    ds_read_b128 a[68:71], v13 offset:45312
    ds_read_b128 a[72:75], v13 offset:46336
    ds_read_b128 a[76:79], v13 offset:47360
    s_waitcnt lgkmcnt(0)
    buffer_load_dwordx4 v[2:5], v9, s[12:15], s57 offen sc1
K_poll:
    s_waitcnt vmcnt(0)
    v_cmp_ne_u32 vcc, s28, v2
    v_cmp_ne_u32 s[32:33], s29, v3
    v_cmp_ne_u32 s[34:35], s28, v4
    s_or_b64 vcc, vcc, s[32:33]
    s_or_b64 vcc, vcc, s[34:35]
    s_cbranch_scc0 K_got
    s_sleep 4
    s_mov_b64 exec, vcc
    buffer_load_dwordx4 v[2:5], v9, s[12:15], s57 offen sc1
    s_mov_b64 exec, -1
    s_add_u32 s26, s26, 1
    s_cmp_lt_u32 s26, 0x200000
    s_cbranch_scc1 K_poll
K_got:
    v_bfe_u32 v5, v5, s60, 8
    s_nop 0
    v_cmp_lt_u32 vcc, 32, v5
    v_mov_b32_dpp v2, v5 quad_perm:[0,0,0,0] row_mask:0xf bank_mask:0xf
    v_mov_b32_dpp v3, v5 quad_perm:[1,1,1,1] row_mask:0xf bank_mask:0xf
    v_and_b32 v4, 3, v0
    v_add_u32 v5, 16, v4
    v_sub_u32 v6, v2, v5
    v_sub_u32 v7, v3, v5
    v_lshlrev_b32 v4, 2, v4
    v_sub_u32 v2, v2, v4
    v_sub_u32 v3, v3, v4
    v_cmp_lt_i32 s[32:33], 0, v2
    s_mov_b64 exec, s[32:33]
    buffer_load_dwordx4 v[16:19], v12, s[12:15], s84 offen sc1
    s_mov_b64 exec, -1
    v_cmp_lt_i32 s[40:41], 0, v3
    s_mov_b64 exec, s[40:41]
    buffer_load_dwordx4 v[20:23], v12, s[12:15], s85 offen sc1
    s_mov_b64 exec, -1
    v_and_b32 v9, 0xffffffc0, v12
    v_or_b32 v9, v9, v4
    v_cmp_lt_i32 s[48:49], 0, v6
    v_cmp_lt_i32 s[50:51], 0, v7
    v_cmp_lt_i32 s[52:53], 4, v6
    v_cmp_lt_i32 s[54:55], 4, v7
    v_cmp_lt_i32 s[56:57], 8, v6
    v_cmp_lt_i32 s[58:59], 8, v7
    v_cmp_lt_i32 s[60:61], 12, v6
    v_cmp_lt_i32 s[62:63], 12, v7
    s_mov_b64 exec, s[48:49]
    buffer_load_dword v24, v9, s[12:15], s86 offen offset:0 sc1
    s_mov_b64 exec, s[50:51]
    buffer_load_dword v25, v9, s[12:15], s87 offen offset:0 sc1
    s_mov_b64 exec, s[52:53]
    buffer_load_dword v26, v9, s[12:15], s86 offen offset:16 sc1
    s_mov_b64 exec, s[54:55]
    buffer_load_dword v27, v9, s[12:15], s87 offen offset:16 sc1
    s_mov_b64 exec, s[56:57]
    buffer_load_dword v28, v9, s[12:15], s86 offen offset:32 sc1
    s_mov_b64 exec, s[58:59]
    buffer_load_dword v29, v9, s[12:15], s87 offen offset:32 sc1
    s_mov_b64 exec, s[60:61]
    buffer_load_dword v30, v9, s[12:15], s86 offen offset:48 sc1
    s_mov_b64 exec, s[62:63]
    buffer_load_dword v31, v9, s[12:15], s87 offen offset:48 sc1
    s_mov_b64 exec, -1
    v_cmp_lt_i32 s[34:35], 1, v2
    v_cmp_lt_i32 s[36:37], 2, v2
    v_cmp_lt_i32 s[38:39], 3, v2
    v_cmp_lt_i32 s[42:43], 1, v3
    v_cmp_lt_i32 s[44:45], 2, v3
    v_cmp_lt_i32 s[46:47], 3, v3
    s_lshl_b32 s3, s24, 10
    s_add_u32 m0, s3, 63360
    s_add_u32 s30, s3, 0x2000
    v_and_b32 v4, 16, v1
    v_lshlrev_b32 v4, 1, v4
    v_xor_b32 v4, v4, v13
    buffer_load_dwordx4 v4, s[80:83], s3 offen lds
    s_add_u32 m0, m0, 0x2000
    v_mov_b32 v5, 0x7f800000
    v_xor_b32 v4, 64, v4
    buffer_load_dwordx4 v4, s[80:83], s30 offen lds
    global_load_dwordx2 v[168:169], v129, s[96:97] offset:0
    global_load_dwordx2 v[170:171], v129, s[96:97] offset:32
    global_load_dwordx2 v[172:173], v129, s[96:97] offset:64
    global_load_dwordx2 v[174:175], v129, s[96:97] offset:96
    v_cndmask_b32 v164, v164, v5, vcc
    v_add_u32 v13, 320000, v11
    v_lshlrev_b32 v10, 2, v1
    v_mov_b32 v4, 0xfc
    v_mov_b32 v5, 8
    s_mov_b32 s30, 0x3fff
    s_waitcnt vmcnt(15)
    v_and_b32_sdwa v32, v16, v4 dst_sel:DWORD dst_unused:UNUSED_PAD src0_sel:BYTE_3 src1_sel:DWORD
    v_and_b32_sdwa v33, v17, v4 dst_sel:DWORD dst_unused:UNUSED_PAD src0_sel:BYTE_3 src1_sel:DWORD
    v_and_b32_sdwa v34, v18, v4 dst_sel:DWORD dst_unused:UNUSED_PAD src0_sel:BYTE_3 src1_sel:DWORD
    v_and_b32_sdwa v35, v19, v4 dst_sel:DWORD dst_unused:UNUSED_PAD src0_sel:BYTE_3 src1_sel:DWORD
    s_mov_b64 exec, s[32:33]
    ds_add_rtn_u32 v48, v32, v5 offset:1536
    s_mov_b64 exec, s[34:35]
    ds_add_rtn_u32 v49, v33, v5 offset:1536
    s_mov_b64 exec, s[36:37]
    ds_add_rtn_u32 v50, v34, v5 offset:1536
    s_mov_b64 exec, s[38:39]
    ds_add_rtn_u32 v51, v35, v5 offset:1536
    s_mov_b64 exec, -1
    s_waitcnt vmcnt(14)
    v_and_b32_sdwa v36, v20, v4 dst_sel:DWORD dst_unused:UNUSED_PAD src0_sel:BYTE_3 src1_sel:DWORD
    v_and_b32_sdwa v37, v21, v4 dst_sel:DWORD dst_unused:UNUSED_PAD src0_sel:BYTE_3 src1_sel:DWORD
    v_and_b32_sdwa v38, v22, v4 dst_sel:DWORD dst_unused:UNUSED_PAD src0_sel:BYTE_3 src1_sel:DWORD
    v_and_b32_sdwa v39, v23, v4 dst_sel:DWORD dst_unused:UNUSED_PAD src0_sel:BYTE_3 src1_sel:DWORD
    s_mov_b64 exec, s[40:41]
    ds_add_rtn_u32 v52, v36, v5 offset:1536
    s_mov_b64 exec, s[42:43]
    ds_add_rtn_u32 v53, v37, v5 offset:1536
    s_mov_b64 exec, s[44:45]
    ds_add_rtn_u32 v54, v38, v5 offset:1536
    s_mov_b64 exec, s[46:47]
    ds_add_rtn_u32 v55, v39, v5 offset:1536
    s_mov_b64 exec, -1
    v_bfe_u32 v65, v16, 14, 12
    v_lshlrev_b32 v64, 19, v32
    v_add_u32 v65, v65, v11
    v_and_or_b32 v64, v16, s30, v64
    v_bfe_u32 v67, v17, 14, 12
    v_lshlrev_b32 v66, 19, v33
    v_add_u32 v67, v67, v11
    v_and_or_b32 v66, v17, s30, v66
    v_bfe_u32 v69, v18, 14, 12
    v_lshlrev_b32 v68, 19, v34
    v_add_u32 v69, v69, v11
    v_and_or_b32 v68, v18, s30, v68
    v_bfe_u32 v71, v19, 14, 12
    v_lshlrev_b32 v70, 19, v35
    v_add_u32 v71, v71, v11
    v_and_or_b32 v70, v19, s30, v70
    v_bfe_u32 v73, v20, 14, 12
    v_lshlrev_b32 v72, 19, v36
    v_add_u32 v73, v73, v13
    v_and_or_b32 v72, v20, s30, v72
    v_bfe_u32 v75, v21, 14, 12
    v_lshlrev_b32 v74, 19, v37
    v_add_u32 v75, v75, v13
    v_and_or_b32 v74, v21, s30, v74
    v_bfe_u32 v77, v22, 14, 12
    v_lshlrev_b32 v76, 19, v38
    v_add_u32 v77, v77, v13
    v_and_or_b32 v76, v22, s30, v76
    v_bfe_u32 v79, v23, 14, 12
    v_lshlrev_b32 v78, 19, v39
    v_add_u32 v79, v79, v13
    v_and_or_b32 v78, v23, s30, v78
    s_waitcnt vmcnt(12)
    v_and_b32_sdwa v40, v24, v4 dst_sel:DWORD dst_unused:UNUSED_PAD src0_sel:BYTE_3 src1_sel:DWORD
    v_and_b32_sdwa v41, v25, v4 dst_sel:DWORD dst_unused:UNUSED_PAD src0_sel:BYTE_3 src1_sel:DWORD
    s_mov_b64 exec, s[48:49]
    ds_add_rtn_u32 v56, v40, v5 offset:1536
    s_mov_b64 exec, s[50:51]
    ds_add_rtn_u32 v57, v41, v5 offset:1536
    s_mov_b64 exec, -1
    v_bfe_u32 v81, v24, 14, 12
    v_lshlrev_b32 v80, 19, v40
    v_add_u32 v81, v81, v11
    v_and_or_b32 v80, v24, s30, v80
    v_bfe_u32 v83, v25, 14, 12
    v_lshlrev_b32 v82, 19, v41
    v_add_u32 v83, v83, v13
    v_and_or_b32 v82, v25, s30, v82
    s_or_b64 vcc, s[52:53], s[54:55]
    s_cbranch_scc1 F_sa_more
F_sa_done:
    s_mul_i32 s98, s24, 40
    s_lshr_b32 s99, s2, 3
    s_mul_i32 s99, s99, 320
    s_add_u32 s98, s98, s99
    v_add_u32 v130, s98, v1
    s_mov_b32 exec_lo, 0xffffffff
    s_mov_b32 exec_hi, 0xff
    buffer_load_dword v131, v130, s[4:7], 0 idxen offset:3072
    s_mov_b64 exec, -1
    s_waitcnt lgkmcnt(0)
    s_barrier
    ds_read_b32 v6, v10 offset:1536
    s_waitcnt lgkmcnt(0)
    v_add_u32 v8, 24, v6
    v_and_b32 v8, 0xffffffe0, v8
    v_mov_b32 v7, v8
    s_nop 1
    v_add_u32_dpp v7, v7, v7 row_shr:1 row_mask:0xf bank_mask:0xf
    s_nop 1
    v_add_u32_dpp v7, v7, v7 row_shr:2 row_mask:0xf bank_mask:0xf
    s_nop 1
    v_add_u32_dpp v7, v7, v7 row_shr:4 row_mask:0xf bank_mask:0xf
    s_nop 1
    v_add_u32_dpp v7, v7, v7 row_shr:8 row_mask:0xf bank_mask:0xf
    s_nop 1
    v_add_u32_dpp v7, v7, v7 row_bcast:15 row_mask:0xa bank_mask:0xf
    s_nop 1
    v_add_u32_dpp v7, v7, v7 row_bcast:31 row_mask:0xc bank_mask:0xf
    v_sub_u32 v8, v7, v8
    v_subrev_u32 v9, 32, v7
    ds_write_b32 v10, v8 offset:1792
    v_readlane_b32 s72, v7, 63
    ds_write_b32 v10, v6 offset:512
    ds_read_b32 v96, v32 offset:1792
    ds_read_b32 v97, v33 offset:1792
    ds_read_b32 v98, v34 offset:1792
    ds_read_b32 v99, v35 offset:1792
    ds_read_b32 v100, v36 offset:1792
    ds_read_b32 v101, v37 offset:1792
    ds_read_b32 v102, v38 offset:1792
    ds_read_b32 v103, v39 offset:1792
    ds_read_b32 v104, v40 offset:1792
    ds_read_b32 v105, v41 offset:1792
    s_lshr_b32 s72, s72, 5
    s_cmp_gt_u32 s72, 768
    s_cbranch_scc1 K_SLOW
    s_add_u32 s30, s72, 31
    s_lshr_b32 s30, s30, 5
    s_mul_i32 s70, s30, 42
    s_add_u32 s70, s70, 32
    s_lshr_b32 s70, s70, 6
    s_lshl_b32 s31, s70, 5
    s_sub_i32 s91, s72, s31
    s_max_i32 s91, s91, 0
    s_add_u32 s91, s91, 7
    s_bfe_u32 s100, s91, 0x20003
    s_lshr_b32 s91, s91, 5
    s_add_u32 s71, s91, 1
    s_and_b32 s30, s24, 3
    s_cmp_lt_u32 s30, s100
    s_cselect_b32 s25, s71, s91
    s_min_u32 s90, s30, s100
    s_mul_i32 s65, s30, s91
    s_add_u32 s65, s65, s90
    s_lshl_b32 s65, s65, 3
    s_add_u32 s65, s65, s31
    s_mul_i32 s30, s30, s70
    s_lshl_b32 s30, s30, 3
    s_cmp_lt_u32 s24, 4
    s_cselect_b32 s25, s70, s25
    s_cselect_b32 s65, s30, s65
    s_lshl_b32 s100, s100, 3
    s_mul_i32 s90, s100, s71
    s_add_u32 s90, s90, s31
    s_add_u32 s100, s100, 32
    s_lshl_b32 s30, s25, 5
    s_lshl_b32 s31, s65, 5
    v_mad_u32_u24 v149, v149, s30, v142
    v_add_u32 v149, s31, v149
    v_mad_u32_u24 v148, v148, s30, v140
    v_add_u32 v148, s31, v148
    v_mad_u32_u24 v146, v146, s30, v147
    v_add_u32 v146, s31, v146
    s_lshl_b32 s30, s30, 2
    v_add_u32 v147, s30, v146
    s_waitcnt lgkmcnt(9)
    v_add_u32 v48, v48, v96
    s_mov_b64 exec, s[32:33]
    ds_write_b64 v48, v[64:65] offset:3200
    s_mov_b64 exec, -1
    s_waitcnt lgkmcnt(9)
    v_add_u32 v49, v49, v97
    s_mov_b64 exec, s[34:35]
    ds_write_b64 v49, v[66:67] offset:3200
    s_mov_b64 exec, -1
    s_waitcnt lgkmcnt(9)
    v_add_u32 v50, v50, v98
    s_mov_b64 exec, s[36:37]
    ds_write_b64 v50, v[68:69] offset:3200
    s_mov_b64 exec, -1
    s_waitcnt lgkmcnt(9)
    v_add_u32 v51, v51, v99
    s_mov_b64 exec, s[38:39]
    ds_write_b64 v51, v[70:71] offset:3200
    s_mov_b64 exec, -1
    s_waitcnt lgkmcnt(9)
    v_add_u32 v52, v52, v100
    s_mov_b64 exec, s[40:41]
    ds_write_b64 v52, v[72:73] offset:3200
    s_mov_b64 exec, -1
    s_waitcnt lgkmcnt(9)
    v_add_u32 v53, v53, v101
    s_mov_b64 exec, s[42:43]
    ds_write_b64 v53, v[74:75] offset:3200
    s_mov_b64 exec, -1
    s_waitcnt lgkmcnt(9)
    v_add_u32 v54, v54, v102
    s_mov_b64 exec, s[44:45]
    ds_write_b64 v54, v[76:77] offset:3200
    s_mov_b64 exec, -1
    s_waitcnt lgkmcnt(9)
    v_add_u32 v55, v55, v103
    s_mov_b64 exec, s[46:47]
    ds_write_b64 v55, v[78:79] offset:3200
    s_mov_b64 exec, -1
    s_waitcnt lgkmcnt(9)
    v_add_u32 v56, v56, v104
    s_mov_b64 exec, s[48:49]
    ds_write_b64 v56, v[80:81] offset:3200
    s_mov_b64 exec, -1
    s_waitcnt lgkmcnt(9)
    v_add_u32 v57, v57, v105
    s_mov_b64 exec, s[50:51]
    ds_write_b64 v57, v[82:83] offset:3200
    s_mov_b64 exec, -1
    s_or_b64 vcc, s[52:53], s[54:55]
    s_cbranch_scc1 F_sb_more
F_sb_done:
    s_waitcnt vmcnt(1) lgkmcnt(0)
    s_barrier
    s_sub_u32 s26, s25, 1
    v_cmp_ne_u32 vcc, 0, v6
    v_bfrev_b32 v2, 1
    ds_read_b32 v140, v148 offset:3204
    ds_read_u16 v132, v146 offset:3200
    ds_read_u16 v134, v146 offset:3216
    ds_read_u16 v136, v147 offset:3200
    ds_read_u16 v138, v147 offset:3216
    s_mov_b64 exec, vcc
    ds_or_b32 v9, v2 offset:3200
    s_mov_b64 exec, -1
    ds_read_u16 v142, v149 offset:3202
    s_cmp_gt_u32 s25, 0
    s_cselect_b32 s6, 10000, 0
    s_cselect_b32 s10, 640000, 0
    s_cmp_ge_u32 s24, 4
    s_cbranch_scc1 F_late0
    s_waitcnt lgkmcnt(2)
    s_add_u32 m0, s27, 4096
    s_nop 0
    buffer_load_dwordx4 v[140:141], s[8:11], 0 idxen offen lds
    s_add_u32 m0, s27, 0
    s_nop 0
    buffer_load_dwordx4 v[132:133], s[4:7], 0 idxen offen offset:0 lds
    buffer_load_dwordx4 v[134:135], s[4:7], 0 idxen offen offset:1024 lds
    buffer_load_dwordx4 v[136:137], s[4:7], 0 idxen offen offset:2048 lds
    buffer_load_dwordx4 v[138:139], s[4:7], 0 idxen offen offset:3072 lds
F_late0:
    s_lshl_b32 s30, s65, 5
    v_cmp_ge_u32 vcc, s30, v7
    s_bcnt1_i32_b64 s76, vcc
    s_lshl_b32 s30, s25, 3
    s_add_u32 s30, s30, s65
    s_min_u32 s30, s30, s72
    s_lshl_b32 s30, s30, 5
    v_cmp_gt_u32 vcc, s30, v7
    s_bcnt1_i32_b64 s101, vcc
    s_sub_i32 s101, s101, s76
    s_cmp_ge_i32 s101, 8
    s_cbranch_scc1 F_q16
    s_lshr_b32 s30, s76, 3
    s_min_u32 s30, s30, 5
    s_lshl_b32 s30, s30, 4
    s_add_u32 s31, s30, 16
    s_min_u32 s31, s31, 80
    v_and_b32 v2, 31, v1
    v_mul_u32_u24 v2, 112, v2
    v_lshrrev_b32 v4, 1, v155
    v_add3_u32 v3, v2, v4, s31
    v_add3_u32 v2, v2, v4, s30
    ds_read_b64 v[88:89], v2 offset:49024
    ds_read_b64 v[32:33], v3 offset:49024
    ds_read_b64 v[90:91], v2 offset:52608
    ds_read_b64 v[34:35], v3 offset:52608
    ds_read_b64 v[92:93], v2 offset:56192
    ds_read_b64 v[36:37], v3 offset:56192
    ds_read_b64 v[94:95], v2 offset:59776
    ds_read_b64 v[38:39], v3 offset:59776
    s_and_b32 s76, s76, 7
    v_lshrrev_b32 v3, 1, v4
    v_sub_u32 v3, s76, v3
    v_mov_b32 v4, 0xffff
    v_cmp_lt_i32 s[78:79], 0, v3
    v_cmp_lt_i32 s[80:81], 1, v3
    s_nop 0
    v_cndmask_b32 v48, 0, v4, s[78:79]
    v_cndmask_b32 v48, v48, -1, s[80:81]
    v_cmp_lt_i32 s[78:79], 2, v3
    v_cmp_lt_i32 s[80:81], 3, v3
    s_nop 0
    v_cndmask_b32 v49, 0, v4, s[78:79]
    v_cndmask_b32 v49, v49, -1, s[80:81]
    s_waitcnt lgkmcnt(0)
    v_bfi_b32 v88, v48, v32, v88
    v_bfi_b32 v89, v49, v33, v89
    v_bfi_b32 v90, v48, v34, v90
    v_bfi_b32 v91, v49, v35, v91
    v_bfi_b32 v92, v48, v36, v92
    v_bfi_b32 v93, v49, v37, v93
    v_bfi_b32 v94, v48, v38, v94
    v_bfi_b32 v95, v49, v39, v95
F_qdone:
    v_cvt_f32_u32 v4, s70
    v_cvt_f32_u32 v5, s71
    v_cvt_f32_u32 v3, s91
    v_rcp_f32 v4, v4
    v_rcp_f32 v5, v5
    v_rcp_f32 v3, v3
    s_lshl_b32 s30, s70, 5
    v_lshrrev_b32 v10, 5, v8
    v_subrev_u32 v11, s30, v10
    v_subrev_u32 v157, s90, v10
    v_cmp_gt_u32 vcc, s30, v10
    v_cmp_gt_u32 s[78:79], s90, v10
    v_cvt_f32_u32 v10, v10
    v_cvt_f32_i32 v11, v11
    v_cvt_f32_i32 v157, v157
    v_add_f32 v10, 0.5, v10
    v_add_f32 v11, 0.5, v11
    v_add_f32 v157, 0.5, v157
    v_mul_f32 v10, v10, v4
    v_mul_f32 v11, v11, v5
    v_mul_f32 v157, v157, v3
    v_cvt_u32_f32 v10, v10
    v_cvt_u32_f32 v11, v11
    v_cvt_u32_f32 v157, v157
    v_min_u32 v157, 32, v157
    v_add_u32 v11, 32, v11
    v_add_u32 v157, s100, v157
    v_min_u32 v157, 64, v157
    v_cndmask_b32 v11, v157, v11, s[78:79]
    v_cndmask_b32 v12, v11, v10, vcc
    v_lshrrev_b32 v10, 5, v7
    v_subrev_u32 v11, s30, v10
    v_subrev_u32 v157, s90, v10
    v_cmp_gt_u32 vcc, s30, v10
    v_cmp_gt_u32 s[78:79], s90, v10
    v_cvt_f32_u32 v10, v10
    v_cvt_f32_i32 v11, v11
    v_cvt_f32_i32 v157, v157
    v_add_f32 v10, 0.5, v10
    v_add_f32 v11, 0.5, v11
    v_add_f32 v157, 0.5, v157
    v_mul_f32 v10, v10, v4
    v_mul_f32 v11, v11, v5
    v_mul_f32 v157, v157, v3
    v_cvt_u32_f32 v10, v10
    v_cvt_u32_f32 v11, v11
    v_cvt_u32_f32 v157, v157
    v_min_u32 v157, 32, v157
    v_add_u32 v11, 32, v11
    v_add_u32 v157, s100, v157
    v_min_u32 v157, 64, v157
    v_cndmask_b32 v11, v157, v11, s[78:79]
    v_cndmask_b32 v13, v11, v10, vcc
    v_lshl_or_b32 v15, v13, 8, v12
    s_cmp_lt_u32 s24, 4
    s_cbranch_scc1 F_early0
    s_add_u32 m0, s27, 4096
    s_nop 0
    buffer_load_dwordx4 v[140:141], s[8:11], 0 idxen offen lds
    s_add_u32 m0, s27, 0
    s_nop 0
    buffer_load_dwordx4 v[132:133], s[4:7], 0 idxen offen offset:0 lds
    buffer_load_dwordx4 v[134:135], s[4:7], 0 idxen offen offset:1024 lds
    buffer_load_dwordx4 v[136:137], s[4:7], 0 idxen offen offset:2048 lds
    buffer_load_dwordx4 v[138:139], s[4:7], 0 idxen offen offset:3072 lds
F_early0:
    ds_read_b32 v140, v148 offset:3236
    ds_read_u16 v132, v146 offset:3232
    ds_read_u16 v134, v146 offset:3248
    ds_read_u16 v136, v147 offset:3232
    ds_read_u16 v138, v147 offset:3248
    v_and_or_b32 v144, v142, s64, v155
    v_pk_mov_b32 v[104:105], 0, 0
    v_pk_mov_b32 v[106:107], 0, 0
    v_pk_mov_b32 v[108:109], 0, 0
    v_pk_mov_b32 v[110:111], 0, 0
    v_pk_mov_b32 v[112:113], 0, 0
    v_pk_mov_b32 v[114:115], 0, 0
    v_pk_mov_b32 v[116:117], 0, 0
    v_pk_mov_b32 v[118:119], 0, 0
    v_pk_mov_b32 v[120:121], 0, 0
    v_pk_mov_b32 v[122:123], 0, 0
    v_mov_b32 v124, 1.0
    v_mov_b32 v125, 1.0
    v_mov_b32 v126, 1.0
    v_mov_b32 v127, 1.0
    v_cmp_eq_u32 vcc, 2, v1
    v_mov_b32 v2, 0x8000
    s_cmp_gt_u32 s25, 1
    s_cselect_b32 s6, 10000, 0
    s_cselect_b32 s10, 640000, 0
    v_cndmask_b32 v143, 0, v2, vcc
    s_cmp_ge_u32 s24, 4
    s_cbranch_scc1 F_b1
    s_waitcnt lgkmcnt(0)
    s_add_u32 m0, s27, 9216
    s_nop 0
    buffer_load_dwordx4 v[140:141], s[8:11], 0 idxen offen lds
    s_add_u32 m0, s27, 5120
    s_nop 0
    buffer_load_dwordx4 v[132:133], s[4:7], 0 idxen offen offset:0 lds
    buffer_load_dwordx4 v[134:135], s[4:7], 0 idxen offen offset:1024 lds
    buffer_load_dwordx4 v[136:137], s[4:7], 0 idxen offen offset:2048 lds
    buffer_load_dwordx4 v[138:139], s[4:7], 0 idxen offen offset:3072 lds
F_b1:
    s_sub_u32 s3, s24, 0
    s_and_b32 s3, s3, 3
    s_lshl_b32 s3, s3, 4
    v_and_b32 v4, 15, v1
    v_add_u32 v4, s3, v4
    v_lshlrev_b32 v5, 2, v4
    ds_bpermute_b32 v6, v5, v15
    ds_read_b32 v5, v5 offset:512
    v_lshrrev_b32 v2, 4, v1
    v_lshlrev_b32 v9, 3, v2
    v_and_b32 v8, 1, v2
    v_lshrrev_b32 v2, 1, v2
    v_lshl_or_b32 v2, v8, 1, v2
    v_bfe_u32 v3, v1, 2, 2
    v_lshl_add_u32 v3, v2, 5, v3
    v_lshlrev_b32 v3, 7, v3
    v_and_b32 v7, 3, v1
    v_lshl_add_u32 v3, v7, 3, v3
    v_bfe_u32 v7, v1, 3, 2
    v_lshl_add_u32 v3, v7, 5, v3
    v_add_u32 v3, 63360, v3
    v_lshlrev_b32 v2, 7, v2
    v_mul_u32_u24 v8, 528, v4
    v_add_u32 v8, 27904, v8
    v_lshl_add_u32 v4, v4, 8, s73
    v_lshl_add_u32 v4, v4, 7, v9
    v_mov_b32 v11, 2048
    s_waitcnt lgkmcnt(0)
    v_cmp_ne_u32 vcc, 0, v5
    v_lshrrev_b32 v7, 8, v6
    v_and_b32 v6, 0xff, v6
    v_cndmask_b32 v8, v11, v8, vcc
    v_add_u32 v8, v8, v2
    v_lshrrev_b32 v5, 3, v5
    v_cvt_f32_u32 v12, v5
    v_lshrrev_b32 v157, 3, v6
    v_and_b32 v158, 7, v6
    v_cmp_lt_u32 vcc, v6, v7
    v_mov_b32 v159, 2048
    v_mul_u32_u24 v157, 10368, v157
    v_mul_u32_u24 v158, 528, v158
    v_add_u32 v157, 79744, v157
    v_add_u32 v157, v157, v158
    v_cndmask_b32 v157, v159, v157, vcc
    v_add_u32 v9, v157, v2
    v_add_u32 v6, 1, v6
    v_lshrrev_b32 v157, 3, v6
    v_and_b32 v158, 7, v6
    v_cmp_lt_u32 vcc, v6, v7
    v_mov_b32 v159, 2048
    v_mul_u32_u24 v157, 10368, v157
    v_mul_u32_u24 v158, 528, v158
    v_add_u32 v157, 79744, v157
    v_add_u32 v157, v157, v158
    v_cndmask_b32 v157, v159, v157, vcc
    v_add_u32 v10, v157, v2
    v_add_u32 v6, 1, v6
    v_lshrrev_b32 v157, 3, v6
    v_and_b32 v158, 7, v6
    v_cmp_lt_u32 vcc, v6, v7
    v_mov_b32 v159, 2048
    v_mul_u32_u24 v157, 10368, v157
    v_mul_u32_u24 v158, 528, v158
    v_add_u32 v157, 79744, v157
    v_add_u32 v157, v157, v158
    v_cndmask_b32 v157, v159, v157, vcc
    v_add_u32 v11, v157, v2
    v_add_u32 v6, 1, v6
    s_cmp_ge_u32 s24, 4
    s_cbranch_scc1 F_b2
    s_waitcnt vmcnt(5)
    s_branch F_a1
F_b2:
    s_waitcnt vmcnt(0)
F_a1:
    s_cmp_lt_u32 s24, 4
    s_cbranch_scc0 F_nopr
    s_setprio 1
F_nopr:
    s_cmp_ge_i32 s101, 8
    s_cbranch_scc1 G_start
    ds_read_b128 v[64:67], v150 offset:0
    ds_read_b128 v[68:71], v151 offset:0
    ds_read_b128 v[72:75], v152 offset:0
    ds_read_b128 v[76:79], v153 offset:0
    ds_read_b128 v[80:83], v154 offset:0
    ds_read_b64 v[84:85], v144 offset:1024
    s_waitcnt lgkmcnt(5)
    v_mfma_f32_32x32x16_bf16 v[16:31], v[64:67], a[0:3], 0
    s_waitcnt lgkmcnt(4)
    v_mfma_f32_32x32x16_bf16 v[16:31], v[68:71], a[16:19], v[16:31]
    s_waitcnt lgkmcnt(3)
    v_mfma_f32_32x32x16_bf16 v[16:31], v[72:75], a[32:35], v[16:31]
    s_waitcnt lgkmcnt(2)
    v_mfma_f32_32x32x16_bf16 v[16:31], v[76:79], a[48:51], v[16:31]
    s_waitcnt lgkmcnt(1)
    v_mfma_f32_32x32x16_bf16 v[16:31], v[80:83], a[64:67], v[16:31]
    s_waitcnt lgkmcnt(0)
    v_mfma_f32_32x32x8_bf16 v[16:31], v[84:85], v[88:89], v[16:31]
    s_cmp_lt_u32 s24, 4
    s_cbranch_scc1 F_a2
    s_add_u32 m0, s27, 9216
    s_nop 0
    buffer_load_dwordx4 v[140:141], s[8:11], 0 idxen offen lds
    s_add_u32 m0, s27, 5120
    s_nop 0
    buffer_load_dwordx4 v[132:133], s[4:7], 0 idxen offen offset:0 lds
    buffer_load_dwordx4 v[134:135], s[4:7], 0 idxen offen offset:1024 lds
    buffer_load_dwordx4 v[136:137], s[4:7], 0 idxen offen offset:2048 lds
    buffer_load_dwordx4 v[138:139], s[4:7], 0 idxen offen offset:3072 lds
F_a2:
    s_nop 5
    ds_read_b32 v140, v148 offset:3268
    ds_read_u16 v132, v146 offset:3264
    ds_read_u16 v134, v146 offset:3280
    ds_read_u16 v136, v147 offset:3264
    ds_read_u16 v138, v147 offset:3280
    s_cmp_eq_u32 s25, 0
    s_cbranch_scc1 F_tail1
F_it0:
    v_mfma_f32_32x32x16_bf16 v[32:47], v[64:67], a[4:7], 0
    v_rcp_f32 v128, v124
    v_rcp_f32 v129, v125
    v_rcp_f32 v130, v126
    v_mfma_f32_32x32x16_bf16 v[32:47], v[68:71], a[20:23], v[32:47]
    v_rcp_f32 v131, v127
    v_exp_f32 v48, v16
    v_exp_f32 v49, v17
    v_mfma_f32_32x32x16_bf16 v[32:47], v[72:75], a[36:39], v[32:47]
    v_exp_f32 v56, v24
    v_exp_f32 v57, v25
    v_exp_f32 v50, v18
    v_mfma_f32_32x32x16_bf16 v[32:47], v[76:79], a[52:55], v[32:47]
    v_exp_f32 v51, v19
    v_exp_f32 v58, v26
    v_exp_f32 v59, v27
    v_mfma_f32_32x32x16_bf16 v[32:47], v[80:83], a[68:71], v[32:47]
    v_exp_f32 v52, v20
    v_exp_f32 v53, v21
    v_exp_f32 v60, v28
    v_mfma_f32_32x32x8_bf16 v[32:47], v[84:85], v[90:91], v[32:47]
    v_exp_f32 v61, v29
    v_exp_f32 v54, v22
    v_exp_f32 v55, v23
    v_exp_f32 v62, v30
    v_exp_f32 v63, v31
    v_cmp_gt_i16 vcc, 0, v143
    v_pk_fma_f32 v[164:165], v[124:125], v[126:127], v[164:165]
    v_pk_fma_f32 v[116:117], v[120:121], v[128:129], v[116:117]
    v_pk_fma_f32 v[118:119], v[122:123], v[130:131], v[118:119]
    s_cbranch_vccnz F_fl0
F_flr0:
    v_pk_add_f32 v[124:125], v[48:49], 1.0 op_sel_hi:[1,0]
    v_pk_add_f32 v[126:127], v[56:57], 1.0 op_sel_hi:[1,0]
    ds_read_u16 v143, v149 offset:3234
    v_pk_fma_f32 v[120:121], v[16:17], v[50:51], v[16:17]
    v_pk_fma_f32 v[122:123], v[24:25], v[58:59], v[24:25]
    ds_read_b32 v140, v148 offset:3300
    v_pk_fma_f32 v[120:121], v[18:19], v[124:125], v[120:121]
    v_pk_fma_f32 v[122:123], v[26:27], v[126:127], v[122:123]
    ds_read_u16 v132, v146 offset:3296
    v_pk_fma_f32 v[124:125], v[124:125], v[50:51], v[124:125]
    v_pk_fma_f32 v[126:127], v[126:127], v[58:59], v[126:127]
    ds_read_u16 v134, v146 offset:3312
    v_pk_fma_f32 v[120:121], v[120:121], v[52:53], v[120:121]
    v_pk_fma_f32 v[122:123], v[122:123], v[60:61], v[122:123]
    ds_read_u16 v136, v147 offset:3296
    v_pk_fma_f32 v[120:121], v[20:21], v[124:125], v[120:121]
    v_pk_fma_f32 v[122:123], v[28:29], v[126:127], v[122:123]
    ds_read_u16 v138, v147 offset:3312
    v_pk_fma_f32 v[124:125], v[124:125], v[52:53], v[124:125]
    v_pk_fma_f32 v[126:127], v[126:127], v[60:61], v[126:127]
    v_pk_fma_f32 v[120:121], v[120:121], v[54:55], v[120:121]
    v_pk_fma_f32 v[122:123], v[122:123], v[62:63], v[122:123]
    v_pk_fma_f32 v[120:121], v[22:23], v[124:125], v[120:121]
    v_pk_fma_f32 v[122:123], v[30:31], v[126:127], v[122:123]
    v_pk_fma_f32 v[124:125], v[124:125], v[54:55], v[124:125]
    v_pk_fma_f32 v[126:127], v[126:127], v[62:63], v[126:127]
    v_mfma_f32_32x32x16_bf16 v[16:31], v[64:67], a[8:11], 0
    v_rcp_f32 v128, v124
    v_rcp_f32 v129, v125
    v_rcp_f32 v130, v126
    v_mfma_f32_32x32x16_bf16 v[16:31], v[68:71], a[24:27], v[16:31]
    v_rcp_f32 v131, v127
    v_exp_f32 v48, v32
    v_exp_f32 v49, v33
    v_mfma_f32_32x32x16_bf16 v[16:31], v[72:75], a[40:43], v[16:31]
    v_exp_f32 v56, v40
    v_exp_f32 v57, v41
    v_exp_f32 v50, v34
    v_mfma_f32_32x32x16_bf16 v[16:31], v[76:79], a[56:59], v[16:31]
    v_exp_f32 v51, v35
    v_exp_f32 v58, v42
    v_exp_f32 v59, v43
    v_mfma_f32_32x32x16_bf16 v[16:31], v[80:83], a[72:75], v[16:31]
    v_exp_f32 v52, v36
    v_exp_f32 v53, v37
    v_exp_f32 v60, v44
    v_mfma_f32_32x32x8_bf16 v[16:31], v[84:85], v[92:93], v[16:31]
    v_exp_f32 v61, v45
    v_exp_f32 v54, v38
    v_exp_f32 v55, v39
    v_exp_f32 v62, v46
    v_exp_f32 v63, v47
    v_pk_fma_f32 v[164:165], v[124:125], v[126:127], v[164:165]
    v_pk_fma_f32 v[104:105], v[120:121], v[128:129], v[104:105]
    v_pk_fma_f32 v[106:107], v[122:123], v[130:131], v[106:107]
    v_pk_add_f32 v[124:125], v[48:49], 1.0 op_sel_hi:[1,0]
    v_pk_add_f32 v[126:127], v[56:57], 1.0 op_sel_hi:[1,0]
    v_pk_fma_f32 v[120:121], v[32:33], v[50:51], v[32:33]
    v_pk_fma_f32 v[122:123], v[40:41], v[58:59], v[40:41]
    v_pk_fma_f32 v[120:121], v[34:35], v[124:125], v[120:121]
    v_pk_fma_f32 v[122:123], v[42:43], v[126:127], v[122:123]
    v_pk_fma_f32 v[124:125], v[124:125], v[50:51], v[124:125]
    v_pk_fma_f32 v[126:127], v[126:127], v[58:59], v[126:127]
    v_pk_fma_f32 v[120:121], v[120:121], v[52:53], v[120:121]
    v_pk_fma_f32 v[122:123], v[122:123], v[60:61], v[122:123]
    v_pk_fma_f32 v[120:121], v[36:37], v[124:125], v[120:121]
    v_pk_fma_f32 v[122:123], v[44:45], v[126:127], v[122:123]
    v_pk_fma_f32 v[124:125], v[124:125], v[52:53], v[124:125]
    v_pk_fma_f32 v[126:127], v[126:127], v[60:61], v[126:127]
    v_pk_fma_f32 v[120:121], v[120:121], v[54:55], v[120:121]
    v_pk_fma_f32 v[122:123], v[122:123], v[62:63], v[122:123]
    v_pk_fma_f32 v[120:121], v[38:39], v[124:125], v[120:121]
    v_pk_fma_f32 v[122:123], v[46:47], v[126:127], v[122:123]
    v_pk_fma_f32 v[124:125], v[124:125], v[54:55], v[124:125]
    v_pk_fma_f32 v[126:127], v[126:127], v[62:63], v[126:127]
    v_mfma_f32_32x32x16_bf16 v[32:47], v[64:67], a[12:15], 0
    v_rcp_f32 v128, v124
    v_rcp_f32 v129, v125
    v_rcp_f32 v130, v126
    v_mfma_f32_32x32x16_bf16 v[32:47], v[68:71], a[28:31], v[32:47]
    v_rcp_f32 v131, v127
    v_exp_f32 v48, v16
    v_exp_f32 v49, v17
    v_mfma_f32_32x32x16_bf16 v[32:47], v[72:75], a[44:47], v[32:47]
    v_exp_f32 v56, v24
    v_exp_f32 v57, v25
    v_exp_f32 v50, v18
    v_mfma_f32_32x32x16_bf16 v[32:47], v[76:79], a[60:63], v[32:47]
    v_exp_f32 v51, v19
    v_exp_f32 v58, v26
    v_exp_f32 v59, v27
    v_mfma_f32_32x32x16_bf16 v[32:47], v[80:83], a[76:79], v[32:47]
    v_exp_f32 v52, v20
    v_exp_f32 v53, v21
    v_exp_f32 v60, v28
    v_mfma_f32_32x32x8_bf16 v[32:47], v[84:85], v[94:95], v[32:47]
    v_exp_f32 v61, v29
    v_exp_f32 v54, v22
    v_exp_f32 v55, v23
    v_exp_f32 v62, v30
    v_exp_f32 v63, v31
    s_sub_u32 s26, s26, 1
    s_cbranch_scc1 F_last0
    s_waitcnt vmcnt(5) lgkmcnt(0)
    v_and_or_b32 v144, v143, s64, v155
    v_pk_fma_f32 v[164:165], v[124:125], v[126:127], v[164:165]
    ds_read_b128 v[64:67], v150 offset:5120
    v_pk_fma_f32 v[108:109], v[120:121], v[128:129], v[108:109]
    ds_read_b128 v[68:71], v151 offset:5120
    v_pk_fma_f32 v[110:111], v[122:123], v[130:131], v[110:111]
    ds_read_b128 v[72:75], v152 offset:5120
    v_pk_add_f32 v[124:125], v[48:49], 1.0 op_sel_hi:[1,0]
    ds_read_b128 v[76:79], v153 offset:5120
    v_pk_add_f32 v[126:127], v[56:57], 1.0 op_sel_hi:[1,0]
    ds_read_b128 v[80:83], v154 offset:5120
    v_pk_fma_f32 v[120:121], v[16:17], v[50:51], v[16:17]
    ds_read_b64 v[84:85], v144 offset:1024
    v_pk_fma_f32 v[122:123], v[24:25], v[58:59], v[24:25]
    v_pk_fma_f32 v[120:121], v[18:19], v[124:125], v[120:121]
    v_pk_fma_f32 v[122:123], v[26:27], v[126:127], v[122:123]
    v_pk_fma_f32 v[124:125], v[124:125], v[50:51], v[124:125]
    v_pk_fma_f32 v[126:127], v[126:127], v[58:59], v[126:127]
    v_pk_fma_f32 v[120:121], v[120:121], v[52:53], v[120:121]
    v_pk_fma_f32 v[122:123], v[122:123], v[60:61], v[122:123]
    v_pk_fma_f32 v[120:121], v[20:21], v[124:125], v[120:121]
    v_pk_fma_f32 v[122:123], v[28:29], v[126:127], v[122:123]
    v_pk_fma_f32 v[124:125], v[124:125], v[52:53], v[124:125]
    v_pk_fma_f32 v[126:127], v[126:127], v[60:61], v[126:127]
    v_pk_fma_f32 v[120:121], v[120:121], v[54:55], v[120:121]
    v_pk_fma_f32 v[122:123], v[122:123], v[62:63], v[122:123]
    v_pk_fma_f32 v[120:121], v[22:23], v[124:125], v[120:121]
    v_pk_fma_f32 v[122:123], v[30:31], v[126:127], v[122:123]
    v_pk_fma_f32 v[124:125], v[124:125], v[54:55], v[124:125]
    v_pk_fma_f32 v[126:127], v[126:127], v[62:63], v[126:127]
    s_waitcnt lgkmcnt(0)
    v_mfma_f32_32x32x16_bf16 v[16:31], v[64:67], a[0:3], 0
    v_rcp_f32 v128, v124
    v_rcp_f32 v129, v125
    v_rcp_f32 v130, v126
    v_mfma_f32_32x32x16_bf16 v[16:31], v[68:71], a[16:19], v[16:31]
    v_rcp_f32 v131, v127
    v_exp_f32 v48, v32
    v_exp_f32 v49, v33
    v_mfma_f32_32x32x16_bf16 v[16:31], v[72:75], a[32:35], v[16:31]
    v_exp_f32 v56, v40
    v_exp_f32 v57, v41
    v_exp_f32 v50, v34
    v_mfma_f32_32x32x16_bf16 v[16:31], v[76:79], a[48:51], v[16:31]
    v_exp_f32 v51, v35
    v_exp_f32 v58, v42
    v_exp_f32 v59, v43
    v_mfma_f32_32x32x16_bf16 v[16:31], v[80:83], a[64:67], v[16:31]
    v_exp_f32 v52, v36
    v_exp_f32 v53, v37
    v_exp_f32 v60, v44
    v_mfma_f32_32x32x8_bf16 v[16:31], v[84:85], v[88:89], v[16:31]
    v_exp_f32 v61, v45
    v_exp_f32 v54, v38
    v_exp_f32 v55, v39
    v_exp_f32 v62, v46
    v_exp_f32 v63, v47
    v_pk_fma_f32 v[164:165], v[124:125], v[126:127], v[164:165]
    v_pk_fma_f32 v[112:113], v[120:121], v[128:129], v[112:113]
    s_cmp_gt_u32 s26, 1
    v_pk_fma_f32 v[114:115], v[122:123], v[130:131], v[114:115]
    v_pk_add_f32 v[124:125], v[48:49], 1.0 op_sel_hi:[1,0]
    s_cselect_b32 s6, 10000, 0
    v_pk_add_f32 v[126:127], v[56:57], 1.0 op_sel_hi:[1,0]
    v_pk_fma_f32 v[120:121], v[32:33], v[50:51], v[32:33]
    s_cselect_b32 s10, 640000, 0
    v_pk_fma_f32 v[122:123], v[40:41], v[58:59], v[40:41]
    v_pk_fma_f32 v[120:121], v[34:35], v[124:125], v[120:121]
    s_add_u32 m0, s27, 9216
    v_pk_fma_f32 v[122:123], v[42:43], v[126:127], v[122:123]
    v_pk_fma_f32 v[124:125], v[124:125], v[50:51], v[124:125]
    buffer_load_dwordx4 v[140:141], s[8:11], 0 idxen offen lds
    v_pk_fma_f32 v[126:127], v[126:127], v[58:59], v[126:127]
    v_pk_fma_f32 v[120:121], v[120:121], v[52:53], v[120:121]
    s_add_u32 m0, s27, 5120
    v_pk_fma_f32 v[122:123], v[122:123], v[60:61], v[122:123]
    v_pk_fma_f32 v[120:121], v[36:37], v[124:125], v[120:121]
    buffer_load_dwordx4 v[132:133], s[4:7], 0 idxen offen offset:0 lds
    v_pk_fma_f32 v[122:123], v[44:45], v[126:127], v[122:123]
    v_pk_fma_f32 v[124:125], v[124:125], v[52:53], v[124:125]
    buffer_load_dwordx4 v[134:135], s[4:7], 0 idxen offen offset:1024 lds
    v_pk_fma_f32 v[126:127], v[126:127], v[60:61], v[126:127]
    v_pk_fma_f32 v[120:121], v[120:121], v[54:55], v[120:121]
    buffer_load_dwordx4 v[136:137], s[4:7], 0 idxen offen offset:2048 lds
    v_pk_fma_f32 v[122:123], v[122:123], v[62:63], v[122:123]
    v_pk_fma_f32 v[120:121], v[38:39], v[124:125], v[120:121]
    buffer_load_dwordx4 v[138:139], s[4:7], 0 idxen offen offset:3072 lds
    v_pk_fma_f32 v[122:123], v[46:47], v[126:127], v[122:123]
    v_pk_fma_f32 v[124:125], v[124:125], v[54:55], v[124:125]
    v_pk_fma_f32 v[126:127], v[126:127], v[62:63], v[126:127]
F_it1:
    v_mfma_f32_32x32x16_bf16 v[32:47], v[64:67], a[4:7], 0
    v_rcp_f32 v128, v124
    v_rcp_f32 v129, v125
    v_rcp_f32 v130, v126
    v_mfma_f32_32x32x16_bf16 v[32:47], v[68:71], a[20:23], v[32:47]
    v_rcp_f32 v131, v127
    v_exp_f32 v48, v16
    v_exp_f32 v49, v17
    v_mfma_f32_32x32x16_bf16 v[32:47], v[72:75], a[36:39], v[32:47]
    v_exp_f32 v56, v24
    v_exp_f32 v57, v25
    v_exp_f32 v50, v18
    v_mfma_f32_32x32x16_bf16 v[32:47], v[76:79], a[52:55], v[32:47]
    v_exp_f32 v51, v19
    v_exp_f32 v58, v26
    v_exp_f32 v59, v27
    v_mfma_f32_32x32x16_bf16 v[32:47], v[80:83], a[68:71], v[32:47]
    v_exp_f32 v52, v20
    v_exp_f32 v53, v21
    v_exp_f32 v60, v28
    v_mfma_f32_32x32x8_bf16 v[32:47], v[84:85], v[90:91], v[32:47]
    v_exp_f32 v61, v29
    v_exp_f32 v54, v22
    v_exp_f32 v55, v23
    v_exp_f32 v62, v30
    v_exp_f32 v63, v31
    v_cmp_gt_i16 vcc, 0, v142
    v_pk_fma_f32 v[164:165], v[124:125], v[126:127], v[164:165]
    v_pk_fma_f32 v[116:117], v[120:121], v[128:129], v[116:117]
    v_pk_fma_f32 v[118:119], v[122:123], v[130:131], v[118:119]
    s_cbranch_vccnz F_fl1
F_flr1:
    v_pk_add_f32 v[124:125], v[48:49], 1.0 op_sel_hi:[1,0]
    v_pk_add_f32 v[126:127], v[56:57], 1.0 op_sel_hi:[1,0]
    ds_read_u16 v142, v149 offset:3266
    v_pk_fma_f32 v[120:121], v[16:17], v[50:51], v[16:17]
    v_pk_fma_f32 v[122:123], v[24:25], v[58:59], v[24:25]
    ds_read_b32 v140, v148 offset:3332
    v_pk_fma_f32 v[120:121], v[18:19], v[124:125], v[120:121]
    v_pk_fma_f32 v[122:123], v[26:27], v[126:127], v[122:123]
    ds_read_u16 v132, v146 offset:3328
    v_pk_fma_f32 v[124:125], v[124:125], v[50:51], v[124:125]
    v_pk_fma_f32 v[126:127], v[126:127], v[58:59], v[126:127]
    ds_read_u16 v134, v146 offset:3344
    v_pk_fma_f32 v[120:121], v[120:121], v[52:53], v[120:121]
    v_pk_fma_f32 v[122:123], v[122:123], v[60:61], v[122:123]
    ds_read_u16 v136, v147 offset:3328
    v_pk_fma_f32 v[120:121], v[20:21], v[124:125], v[120:121]
    v_pk_fma_f32 v[122:123], v[28:29], v[126:127], v[122:123]
    ds_read_u16 v138, v147 offset:3344
    v_pk_fma_f32 v[124:125], v[124:125], v[52:53], v[124:125]
    v_pk_fma_f32 v[126:127], v[126:127], v[60:61], v[126:127]
    v_pk_fma_f32 v[120:121], v[120:121], v[54:55], v[120:121]
    v_pk_fma_f32 v[122:123], v[122:123], v[62:63], v[122:123]
    v_pk_fma_f32 v[120:121], v[22:23], v[124:125], v[120:121]
    v_pk_fma_f32 v[122:123], v[30:31], v[126:127], v[122:123]
    v_pk_fma_f32 v[124:125], v[124:125], v[54:55], v[124:125]
    v_pk_fma_f32 v[126:127], v[126:127], v[62:63], v[126:127]
    v_mfma_f32_32x32x16_bf16 v[16:31], v[64:67], a[8:11], 0
    v_rcp_f32 v128, v124
    v_rcp_f32 v129, v125
    v_rcp_f32 v130, v126
    v_mfma_f32_32x32x16_bf16 v[16:31], v[68:71], a[24:27], v[16:31]
    v_rcp_f32 v131, v127
    v_exp_f32 v48, v32
    v_exp_f32 v49, v33
    v_mfma_f32_32x32x16_bf16 v[16:31], v[72:75], a[40:43], v[16:31]
    v_exp_f32 v56, v40
    v_exp_f32 v57, v41
    v_exp_f32 v50, v34
    v_mfma_f32_32x32x16_bf16 v[16:31], v[76:79], a[56:59], v[16:31]
    v_exp_f32 v51, v35
    v_exp_f32 v58, v42
    v_exp_f32 v59, v43
    v_mfma_f32_32x32x16_bf16 v[16:31], v[80:83], a[72:75], v[16:31]
    v_exp_f32 v52, v36
    v_exp_f32 v53, v37
    v_exp_f32 v60, v44
    v_mfma_f32_32x32x8_bf16 v[16:31], v[84:85], v[92:93], v[16:31]
    v_exp_f32 v61, v45
    v_exp_f32 v54, v38
    v_exp_f32 v55, v39
    v_exp_f32 v62, v46
    v_exp_f32 v63, v47
    v_pk_fma_f32 v[164:165], v[124:125], v[126:127], v[164:165]
    v_pk_fma_f32 v[104:105], v[120:121], v[128:129], v[104:105]
    v_pk_fma_f32 v[106:107], v[122:123], v[130:131], v[106:107]
    v_pk_add_f32 v[124:125], v[48:49], 1.0 op_sel_hi:[1,0]
    v_pk_add_f32 v[126:127], v[56:57], 1.0 op_sel_hi:[1,0]
    v_pk_fma_f32 v[120:121], v[32:33], v[50:51], v[32:33]
    v_pk_fma_f32 v[122:123], v[40:41], v[58:59], v[40:41]
    v_pk_fma_f32 v[120:121], v[34:35], v[124:125], v[120:121]
    v_pk_fma_f32 v[122:123], v[42:43], v[126:127], v[122:123]
    v_pk_fma_f32 v[124:125], v[124:125], v[50:51], v[124:125]
    v_pk_fma_f32 v[126:127], v[126:127], v[58:59], v[126:127]
    v_pk_fma_f32 v[120:121], v[120:121], v[52:53], v[120:121]
    v_pk_fma_f32 v[122:123], v[122:123], v[60:61], v[122:123]
    v_pk_fma_f32 v[120:121], v[36:37], v[124:125], v[120:121]
    v_pk_fma_f32 v[122:123], v[44:45], v[126:127], v[122:123]
    v_pk_fma_f32 v[124:125], v[124:125], v[52:53], v[124:125]
    v_pk_fma_f32 v[126:127], v[126:127], v[60:61], v[126:127]
    v_pk_fma_f32 v[120:121], v[120:121], v[54:55], v[120:121]
    v_pk_fma_f32 v[122:123], v[122:123], v[62:63], v[122:123]
    v_pk_fma_f32 v[120:121], v[38:39], v[124:125], v[120:121]
    v_pk_fma_f32 v[122:123], v[46:47], v[126:127], v[122:123]
    v_pk_fma_f32 v[124:125], v[124:125], v[54:55], v[124:125]
    v_pk_fma_f32 v[126:127], v[126:127], v[62:63], v[126:127]
    v_mfma_f32_32x32x16_bf16 v[32:47], v[64:67], a[12:15], 0
    v_rcp_f32 v128, v124
    v_rcp_f32 v129, v125
    v_rcp_f32 v130, v126
    v_mfma_f32_32x32x16_bf16 v[32:47], v[68:71], a[28:31], v[32:47]
    v_rcp_f32 v131, v127
    v_exp_f32 v48, v16
    v_exp_f32 v49, v17
    v_mfma_f32_32x32x16_bf16 v[32:47], v[72:75], a[44:47], v[32:47]
    v_exp_f32 v56, v24
    v_exp_f32 v57, v25
    v_exp_f32 v50, v18
    v_mfma_f32_32x32x16_bf16 v[32:47], v[76:79], a[60:63], v[32:47]
    v_exp_f32 v51, v19
    v_exp_f32 v58, v26
    v_exp_f32 v59, v27
    v_mfma_f32_32x32x16_bf16 v[32:47], v[80:83], a[76:79], v[32:47]
    v_exp_f32 v52, v20
    v_exp_f32 v53, v21
    v_exp_f32 v60, v28
    v_mfma_f32_32x32x8_bf16 v[32:47], v[84:85], v[94:95], v[32:47]
    v_exp_f32 v61, v29
    v_exp_f32 v54, v22
    v_exp_f32 v55, v23
    v_exp_f32 v62, v30
    v_exp_f32 v63, v31
    s_sub_u32 s26, s26, 1
    s_cbranch_scc1 F_last1
    s_waitcnt vmcnt(5) lgkmcnt(0)
    v_and_or_b32 v144, v142, s64, v155
    v_pk_fma_f32 v[164:165], v[124:125], v[126:127], v[164:165]
    ds_read_b128 v[64:67], v150 offset:0
    v_pk_fma_f32 v[108:109], v[120:121], v[128:129], v[108:109]
    ds_read_b128 v[68:71], v151 offset:0
    v_pk_fma_f32 v[110:111], v[122:123], v[130:131], v[110:111]
    ds_read_b128 v[72:75], v152 offset:0
    v_pk_add_f32 v[124:125], v[48:49], 1.0 op_sel_hi:[1,0]
    ds_read_b128 v[76:79], v153 offset:0
    v_pk_add_f32 v[126:127], v[56:57], 1.0 op_sel_hi:[1,0]
    ds_read_b128 v[80:83], v154 offset:0
    v_pk_fma_f32 v[120:121], v[16:17], v[50:51], v[16:17]
    ds_read_b64 v[84:85], v144 offset:1024
    v_pk_fma_f32 v[122:123], v[24:25], v[58:59], v[24:25]
    v_pk_fma_f32 v[120:121], v[18:19], v[124:125], v[120:121]
    v_pk_fma_f32 v[122:123], v[26:27], v[126:127], v[122:123]
    v_pk_fma_f32 v[124:125], v[124:125], v[50:51], v[124:125]
    v_pk_fma_f32 v[126:127], v[126:127], v[58:59], v[126:127]
    v_pk_fma_f32 v[120:121], v[120:121], v[52:53], v[120:121]
    v_pk_fma_f32 v[122:123], v[122:123], v[60:61], v[122:123]
    v_pk_fma_f32 v[120:121], v[20:21], v[124:125], v[120:121]
    v_pk_fma_f32 v[122:123], v[28:29], v[126:127], v[122:123]
    v_pk_fma_f32 v[124:125], v[124:125], v[52:53], v[124:125]
    v_pk_fma_f32 v[126:127], v[126:127], v[60:61], v[126:127]
    v_pk_fma_f32 v[120:121], v[120:121], v[54:55], v[120:121]
    v_pk_fma_f32 v[122:123], v[122:123], v[62:63], v[122:123]
    v_pk_fma_f32 v[120:121], v[22:23], v[124:125], v[120:121]
    v_pk_fma_f32 v[122:123], v[30:31], v[126:127], v[122:123]
    v_pk_fma_f32 v[124:125], v[124:125], v[54:55], v[124:125]
    v_pk_fma_f32 v[126:127], v[126:127], v[62:63], v[126:127]
    s_waitcnt lgkmcnt(0)
    v_mfma_f32_32x32x16_bf16 v[16:31], v[64:67], a[0:3], 0
    v_rcp_f32 v128, v124
    v_rcp_f32 v129, v125
    v_rcp_f32 v130, v126
    v_mfma_f32_32x32x16_bf16 v[16:31], v[68:71], a[16:19], v[16:31]
    v_rcp_f32 v131, v127
    v_exp_f32 v48, v32
    v_exp_f32 v49, v33
    v_mfma_f32_32x32x16_bf16 v[16:31], v[72:75], a[32:35], v[16:31]
    v_exp_f32 v56, v40
    v_exp_f32 v57, v41
    v_exp_f32 v50, v34
    v_mfma_f32_32x32x16_bf16 v[16:31], v[76:79], a[48:51], v[16:31]
    v_exp_f32 v51, v35
    v_exp_f32 v58, v42
    v_exp_f32 v59, v43
    v_mfma_f32_32x32x16_bf16 v[16:31], v[80:83], a[64:67], v[16:31]
    v_exp_f32 v52, v36
    v_exp_f32 v53, v37
    v_exp_f32 v60, v44
    v_mfma_f32_32x32x8_bf16 v[16:31], v[84:85], v[88:89], v[16:31]
    v_exp_f32 v61, v45
    v_exp_f32 v54, v38
    v_exp_f32 v55, v39
    v_exp_f32 v62, v46
    v_exp_f32 v63, v47
    v_add_u32 v146, 64, v146
    v_add_u32 v147, 64, v147
    v_add_u32 v148, 64, v148
    v_add_u32 v149, 64, v149
    v_pk_fma_f32 v[164:165], v[124:125], v[126:127], v[164:165]
    v_pk_fma_f32 v[112:113], v[120:121], v[128:129], v[112:113]
    s_cmp_gt_u32 s26, 1
    v_pk_fma_f32 v[114:115], v[122:123], v[130:131], v[114:115]
    v_pk_add_f32 v[124:125], v[48:49], 1.0 op_sel_hi:[1,0]
    s_cselect_b32 s6, 10000, 0
    v_pk_add_f32 v[126:127], v[56:57], 1.0 op_sel_hi:[1,0]
    v_pk_fma_f32 v[120:121], v[32:33], v[50:51], v[32:33]
    s_cselect_b32 s10, 640000, 0
    v_pk_fma_f32 v[122:123], v[40:41], v[58:59], v[40:41]
    v_pk_fma_f32 v[120:121], v[34:35], v[124:125], v[120:121]
    s_add_u32 m0, s27, 4096
    v_pk_fma_f32 v[122:123], v[42:43], v[126:127], v[122:123]
    v_pk_fma_f32 v[124:125], v[124:125], v[50:51], v[124:125]
    buffer_load_dwordx4 v[140:141], s[8:11], 0 idxen offen lds
    v_pk_fma_f32 v[126:127], v[126:127], v[58:59], v[126:127]
    v_pk_fma_f32 v[120:121], v[120:121], v[52:53], v[120:121]
    s_add_u32 m0, s27, 0
    v_pk_fma_f32 v[122:123], v[122:123], v[60:61], v[122:123]
    v_pk_fma_f32 v[120:121], v[36:37], v[124:125], v[120:121]
    buffer_load_dwordx4 v[132:133], s[4:7], 0 idxen offen offset:0 lds
    v_pk_fma_f32 v[122:123], v[44:45], v[126:127], v[122:123]
    v_pk_fma_f32 v[124:125], v[124:125], v[52:53], v[124:125]
    buffer_load_dwordx4 v[134:135], s[4:7], 0 idxen offen offset:1024 lds
    v_pk_fma_f32 v[126:127], v[126:127], v[60:61], v[126:127]
    v_pk_fma_f32 v[120:121], v[120:121], v[54:55], v[120:121]
    buffer_load_dwordx4 v[136:137], s[4:7], 0 idxen offen offset:2048 lds
    v_pk_fma_f32 v[122:123], v[122:123], v[62:63], v[122:123]
    v_pk_fma_f32 v[120:121], v[38:39], v[124:125], v[120:121]
    buffer_load_dwordx4 v[138:139], s[4:7], 0 idxen offen offset:3072 lds
    v_pk_fma_f32 v[122:123], v[46:47], v[126:127], v[122:123]
    v_pk_fma_f32 v[124:125], v[124:125], v[54:55], v[124:125]
    v_pk_fma_f32 v[126:127], v[126:127], v[62:63], v[126:127]
    s_branch F_it0
F_last0:
    s_waitcnt lgkmcnt(0)
    v_mov_b32 v143, v142
F_last1:
    v_pk_fma_f32 v[164:165], v[124:125], v[126:127], v[164:165]
    v_pk_fma_f32 v[108:109], v[120:121], v[128:129], v[108:109]
    v_pk_fma_f32 v[110:111], v[122:123], v[130:131], v[110:111]
    v_pk_add_f32 v[124:125], v[48:49], 1.0 op_sel_hi:[1,0]
    v_pk_add_f32 v[126:127], v[56:57], 1.0 op_sel_hi:[1,0]
    v_pk_fma_f32 v[120:121], v[16:17], v[50:51], v[16:17]
    v_pk_fma_f32 v[122:123], v[24:25], v[58:59], v[24:25]
    v_pk_fma_f32 v[120:121], v[18:19], v[124:125], v[120:121]
    v_pk_fma_f32 v[122:123], v[26:27], v[126:127], v[122:123]
    v_pk_fma_f32 v[124:125], v[124:125], v[50:51], v[124:125]
    v_pk_fma_f32 v[126:127], v[126:127], v[58:59], v[126:127]
    v_pk_fma_f32 v[120:121], v[120:121], v[52:53], v[120:121]
    v_pk_fma_f32 v[122:123], v[122:123], v[60:61], v[122:123]
    v_pk_fma_f32 v[120:121], v[20:21], v[124:125], v[120:121]
    v_pk_fma_f32 v[122:123], v[28:29], v[126:127], v[122:123]
    v_pk_fma_f32 v[124:125], v[124:125], v[52:53], v[124:125]
    v_pk_fma_f32 v[126:127], v[126:127], v[60:61], v[126:127]
    v_pk_fma_f32 v[120:121], v[120:121], v[54:55], v[120:121]
    v_pk_fma_f32 v[122:123], v[122:123], v[62:63], v[122:123]
    v_pk_fma_f32 v[120:121], v[22:23], v[124:125], v[120:121]
    v_pk_fma_f32 v[122:123], v[30:31], v[126:127], v[122:123]
    v_pk_fma_f32 v[124:125], v[124:125], v[54:55], v[124:125]
    v_pk_fma_f32 v[126:127], v[126:127], v[62:63], v[126:127]
    v_rcp_f32 v128, v124
    v_rcp_f32 v129, v125
    v_rcp_f32 v130, v126
    v_rcp_f32 v131, v127
    v_exp_f32 v48, v32
    v_exp_f32 v49, v33
    v_exp_f32 v56, v40
    v_exp_f32 v57, v41
    v_exp_f32 v50, v34
    v_exp_f32 v51, v35
    v_exp_f32 v58, v42
    v_exp_f32 v59, v43
    v_exp_f32 v52, v36
    v_exp_f32 v53, v37
    v_exp_f32 v60, v44
    v_exp_f32 v61, v45
    v_exp_f32 v54, v38
    v_exp_f32 v55, v39
    v_exp_f32 v62, v46
    v_exp_f32 v63, v47
    v_pk_fma_f32 v[164:165], v[124:125], v[126:127], v[164:165]
    v_pk_fma_f32 v[112:113], v[120:121], v[128:129], v[112:113]
    v_pk_fma_f32 v[114:115], v[122:123], v[130:131], v[114:115]
    v_pk_add_f32 v[124:125], v[48:49], 1.0 op_sel_hi:[1,0]
    v_pk_add_f32 v[126:127], v[56:57], 1.0 op_sel_hi:[1,0]
    v_pk_fma_f32 v[120:121], v[32:33], v[50:51], v[32:33]
    v_pk_fma_f32 v[122:123], v[40:41], v[58:59], v[40:41]
    v_pk_fma_f32 v[120:121], v[34:35], v[124:125], v[120:121]
    v_pk_fma_f32 v[122:123], v[42:43], v[126:127], v[122:123]
    v_pk_fma_f32 v[124:125], v[124:125], v[50:51], v[124:125]
    v_pk_fma_f32 v[126:127], v[126:127], v[58:59], v[126:127]
    v_pk_fma_f32 v[120:121], v[120:121], v[52:53], v[120:121]
    v_pk_fma_f32 v[122:123], v[122:123], v[60:61], v[122:123]
    v_pk_fma_f32 v[120:121], v[36:37], v[124:125], v[120:121]
    v_pk_fma_f32 v[122:123], v[44:45], v[126:127], v[122:123]
    v_pk_fma_f32 v[124:125], v[124:125], v[52:53], v[124:125]
    v_pk_fma_f32 v[126:127], v[126:127], v[60:61], v[126:127]
    v_pk_fma_f32 v[120:121], v[120:121], v[54:55], v[120:121]
    v_pk_fma_f32 v[122:123], v[122:123], v[62:63], v[122:123]
    v_pk_fma_f32 v[120:121], v[38:39], v[124:125], v[120:121]
    v_pk_fma_f32 v[122:123], v[46:47], v[126:127], v[122:123]
    v_pk_fma_f32 v[124:125], v[124:125], v[54:55], v[124:125]
    v_pk_fma_f32 v[126:127], v[126:127], v[62:63], v[126:127]
F_tail1:
    v_rcp_f32 v128, v124
    v_rcp_f32 v129, v125
    v_rcp_f32 v130, v126
    v_rcp_f32 v131, v127
    v_pk_fma_f32 v[164:165], v[124:125], v[126:127], v[164:165]
    v_pk_fma_f32 v[116:117], v[120:121], v[128:129], v[116:117]
    v_pk_fma_f32 v[118:119], v[122:123], v[130:131], v[118:119]
    v_cmp_gt_i16 vcc, 0, v143
    s_cbranch_vccnz F_tlfl
F_tl_nofl:
    s_setprio 0
    v_mul_u32_u24 v158, 66, v155
    s_mul_i32 s30, s24, 10368
    s_add_u32 s30, s30, 51840
    v_add3_u32 v157, v156, v158, s30
    v_add_u32 v158, 2112, v157
    s_waitcnt vmcnt(0)
    ds_write2_b32 v157, v104, v108 offset0:0 offset1:32
    ds_write2_b32 v157, v112, v116 offset0:64 offset1:96
    ds_write2_b32 v157, v105, v109 offset0:132 offset1:164
    ds_write2_b32 v157, v113, v117 offset0:196 offset1:228
    ds_write2_b32 v158, v106, v110 offset0:0 offset1:32
    ds_write2_b32 v158, v114, v118 offset0:64 offset1:96
    ds_write2_b32 v158, v107, v111 offset0:132 offset1:164
    ds_write2_b32 v158, v115, v119 offset0:196 offset1:228
    v_pk_fma_f32 v[164:165], v[104:105], 0, v[164:165] op_sel_hi:[1,0,1]
    v_pk_fma_f32 v[164:165], v[106:107], 0, v[164:165] op_sel_hi:[1,0,1]
    v_pk_fma_f32 v[164:165], v[108:109], 0, v[164:165] op_sel_hi:[1,0,1]
    v_pk_fma_f32 v[164:165], v[110:111], 0, v[164:165] op_sel_hi:[1,0,1]
    v_pk_fma_f32 v[164:165], v[112:113], 0, v[164:165] op_sel_hi:[1,0,1]
    v_pk_fma_f32 v[164:165], v[114:115], 0, v[164:165] op_sel_hi:[1,0,1]
    v_pk_fma_f32 v[164:165], v[116:117], 0, v[164:165] op_sel_hi:[1,0,1]
    v_pk_fma_f32 v[164:165], v[118:119], 0, v[164:165] op_sel_hi:[1,0,1]
    s_mov_b32 s3, 2071986176
    v_add_f32 v164, v164, v165
    v_cmp_nge_f32 vcc, s3, v164
    s_cbranch_vccz F_noflag
    v_mov_b32 v5, 0
    v_mov_b32 v157, 1
    ds_write_b32 v5, v157 offset:768
F_noflag:
    s_sub_u32 s3, s24, 0
    s_cmp_ge_u32 s3, 3
    s_cbranch_scc1 F_now2
    ds_read_b64_tr_b16 a[0:1], v3 offset:0
    ds_read_b64_tr_b16 a[2:3], v3 offset:512
    ds_read_b64_tr_b16 a[4:5], v3 offset:1024
    ds_read_b64_tr_b16 a[6:7], v3 offset:1536
    ds_read_b64_tr_b16 a[8:9], v3 offset:2048
    ds_read_b64_tr_b16 a[10:11], v3 offset:2560
    ds_read_b64_tr_b16 a[12:13], v3 offset:3072
    ds_read_b64_tr_b16 a[14:15], v3 offset:3584
    v_xor_b32 v157, 32, v3
    ds_read_b64_tr_b16 a[16:17], v157 offset:0
    ds_read_b64_tr_b16 a[18:19], v157 offset:512
    ds_read_b64_tr_b16 a[20:21], v157 offset:1024
    ds_read_b64_tr_b16 a[22:23], v157 offset:1536
    ds_read_b64_tr_b16 a[24:25], v157 offset:2048
    ds_read_b64_tr_b16 a[26:27], v157 offset:2560
    ds_read_b64_tr_b16 a[28:29], v157 offset:3072
    ds_read_b64_tr_b16 a[30:31], v157 offset:3584
    v_xor_b32 v157, 64, v3
    ds_read_b64_tr_b16 a[32:33], v157 offset:0
    ds_read_b64_tr_b16 a[34:35], v157 offset:512
    ds_read_b64_tr_b16 a[36:37], v157 offset:1024
    ds_read_b64_tr_b16 a[38:39], v157 offset:1536
    ds_read_b64_tr_b16 a[40:41], v157 offset:2048
    ds_read_b64_tr_b16 a[42:43], v157 offset:2560
    ds_read_b64_tr_b16 a[44:45], v157 offset:3072
    ds_read_b64_tr_b16 a[46:47], v157 offset:3584
    v_xor_b32 v157, 96, v3
    ds_read_b64_tr_b16 a[48:49], v157 offset:0
    ds_read_b64_tr_b16 a[50:51], v157 offset:512
    ds_read_b64_tr_b16 a[52:53], v157 offset:1024
    ds_read_b64_tr_b16 a[54:55], v157 offset:1536
    ds_read_b64_tr_b16 a[56:57], v157 offset:2048
    ds_read_b64_tr_b16 a[58:59], v157 offset:2560
    ds_read_b64_tr_b16 a[60:61], v157 offset:3072
    ds_read_b64_tr_b16 a[62:63], v157 offset:3584
F_now2:
    v_mov_b32 v5, 0
    s_waitcnt lgkmcnt(0)
    s_barrier
    ds_read_b32 v5, v5 offset:768
K_FINAL:
    s_cmp_ge_u32 s3, 3
    s_cbranch_scc1 E_idle
    ds_read_b128 v[16:19], v8 offset:0
    ds_read_b128 v[20:23], v8 offset:16
    ds_read_b128 v[24:27], v8 offset:32
    ds_read_b128 v[28:31], v8 offset:48
    ds_read_b128 v[32:35], v8 offset:64
    ds_read_b128 v[36:39], v8 offset:80
    ds_read_b128 v[40:43], v8 offset:96
    ds_read_b128 v[44:47], v8 offset:112
    ds_read_b128 v[48:51], v9 offset:0
    ds_read_b128 v[52:55], v9 offset:16
    ds_read_b128 v[56:59], v9 offset:32
    ds_read_b128 v[60:63], v9 offset:48
    ds_read_b128 v[64:67], v9 offset:64
    ds_read_b128 v[68:71], v9 offset:80
    ds_read_b128 v[72:75], v9 offset:96
    ds_read_b128 v[76:79], v9 offset:112
    ds_read_b128 v[80:83], v10 offset:0
    ds_read_b128 v[84:87], v10 offset:16
    ds_read_b128 v[88:91], v10 offset:32
    ds_read_b128 v[92:95], v10 offset:48
    ds_read_b128 v[96:99], v10 offset:64
    ds_read_b128 v[100:103], v10 offset:80
    ds_read_b128 v[104:107], v10 offset:96
    ds_read_b128 v[108:111], v10 offset:112
    v_lshlrev_b32 v112, 16, v168
    v_and_b32 v113, 0xffff0000, v168
    v_lshlrev_b32 v114, 16, v169
    v_and_b32 v115, 0xffff0000, v169
    v_lshlrev_b32 v116, 16, v170
    v_and_b32 v117, 0xffff0000, v170
    v_lshlrev_b32 v118, 16, v171
    v_and_b32 v119, 0xffff0000, v171
    v_lshlrev_b32 v120, 16, v172
    v_and_b32 v121, 0xffff0000, v172
    v_lshlrev_b32 v122, 16, v173
    v_and_b32 v123, 0xffff0000, v173
    v_lshlrev_b32 v124, 16, v174
    v_and_b32 v125, 0xffff0000, v174
    v_lshlrev_b32 v126, 16, v175
    v_and_b32 v127, 0xffff0000, v175
    v_mul_f32 v112, v12, v112
    v_mul_f32 v113, v12, v113
    v_mul_f32 v114, v12, v114
    v_mul_f32 v115, v12, v115
    v_mul_f32 v116, v12, v116
    v_mul_f32 v117, v12, v117
    v_mul_f32 v118, v12, v118
    v_mul_f32 v119, v12, v119
    v_mul_f32 v120, v12, v120
    v_mul_f32 v121, v12, v121
    v_mul_f32 v122, v12, v122
    v_mul_f32 v123, v12, v123
    v_mul_f32 v124, v12, v124
    v_mul_f32 v125, v12, v125
    v_mul_f32 v126, v12, v126
    v_mul_f32 v127, v12, v127
    s_waitcnt lgkmcnt(8)
    v_cmp_ne_u32 vcc, 0, v5
    s_cbranch_vccnz K_SLOW
    v_pk_add_f32 v[16:17], v[16:17], v[48:49]
    v_pk_add_f32 v[18:19], v[18:19], v[50:51]
    v_pk_add_f32 v[20:21], v[20:21], v[52:53]
    v_pk_add_f32 v[22:23], v[22:23], v[54:55]
    v_pk_add_f32 v[24:25], v[24:25], v[56:57]
    v_pk_add_f32 v[26:27], v[26:27], v[58:59]
    v_pk_add_f32 v[28:29], v[28:29], v[60:61]
    v_pk_add_f32 v[30:31], v[30:31], v[62:63]
    v_pk_add_f32 v[32:33], v[32:33], v[64:65]
    v_pk_add_f32 v[34:35], v[34:35], v[66:67]
    v_pk_add_f32 v[36:37], v[36:37], v[68:69]
    v_pk_add_f32 v[38:39], v[38:39], v[70:71]
    v_pk_add_f32 v[40:41], v[40:41], v[72:73]
    v_pk_add_f32 v[42:43], v[42:43], v[74:75]
    v_pk_add_f32 v[44:45], v[44:45], v[76:77]
    v_pk_add_f32 v[46:47], v[46:47], v[78:79]
    ds_read_b128 v[48:51], v11 offset:0
    ds_read_b128 v[52:55], v11 offset:16
    ds_read_b128 v[56:59], v11 offset:32
    ds_read_b128 v[60:63], v11 offset:48
    ds_read_b128 v[64:67], v11 offset:64
    ds_read_b128 v[68:71], v11 offset:80
    ds_read_b128 v[72:75], v11 offset:96
    ds_read_b128 v[76:79], v11 offset:112
    v_cmp_lt_u32 vcc, v6, v7
    s_waitcnt lgkmcnt(8)
    v_pk_add_f32 v[16:17], v[16:17], v[80:81]
    v_pk_add_f32 v[18:19], v[18:19], v[82:83]
    v_pk_add_f32 v[20:21], v[20:21], v[84:85]
    v_pk_add_f32 v[22:23], v[22:23], v[86:87]
    v_pk_add_f32 v[24:25], v[24:25], v[88:89]
    v_pk_add_f32 v[26:27], v[26:27], v[90:91]
    v_pk_add_f32 v[28:29], v[28:29], v[92:93]
    v_pk_add_f32 v[30:31], v[30:31], v[94:95]
    v_pk_add_f32 v[32:33], v[32:33], v[96:97]
    v_pk_add_f32 v[34:35], v[34:35], v[98:99]
    v_pk_add_f32 v[36:37], v[36:37], v[100:101]
    v_pk_add_f32 v[38:39], v[38:39], v[102:103]
    v_pk_add_f32 v[40:41], v[40:41], v[104:105]
    v_pk_add_f32 v[42:43], v[42:43], v[106:107]
    v_pk_add_f32 v[44:45], v[44:45], v[108:109]
    v_pk_add_f32 v[46:47], v[46:47], v[110:111]
    s_waitcnt lgkmcnt(0)
    v_pk_add_f32 v[16:17], v[16:17], v[48:49]
    v_pk_add_f32 v[18:19], v[18:19], v[50:51]
    v_pk_add_f32 v[20:21], v[20:21], v[52:53]
    v_pk_add_f32 v[22:23], v[22:23], v[54:55]
    v_pk_add_f32 v[24:25], v[24:25], v[56:57]
    v_pk_add_f32 v[26:27], v[26:27], v[58:59]
    v_pk_add_f32 v[28:29], v[28:29], v[60:61]
    v_pk_add_f32 v[30:31], v[30:31], v[62:63]
    v_pk_add_f32 v[32:33], v[32:33], v[64:65]
    v_pk_add_f32 v[34:35], v[34:35], v[66:67]
    v_pk_add_f32 v[36:37], v[36:37], v[68:69]
    v_pk_add_f32 v[38:39], v[38:39], v[70:71]
    v_pk_add_f32 v[40:41], v[40:41], v[72:73]
    v_pk_add_f32 v[42:43], v[42:43], v[74:75]
    v_pk_add_f32 v[44:45], v[44:45], v[76:77]
    v_pk_add_f32 v[46:47], v[46:47], v[78:79]
    s_cbranch_vccnz E_more
E_sum:
    s_mov_b32 s3, 3207688728
    v_cvt_pk_bf16_f32 v48, v16, v17
    v_cvt_pk_bf16_f32 v49, v18, v19
    v_cvt_pk_bf16_f32 v50, v20, v21
    v_cvt_pk_bf16_f32 v51, v22, v23
    v_cvt_pk_bf16_f32 v52, v24, v25
    v_cvt_pk_bf16_f32 v53, v26, v27
    v_cvt_pk_bf16_f32 v54, v28, v29
    v_cvt_pk_bf16_f32 v55, v30, v31
    v_mfma_f32_16x16x32_bf16 v[80:83], a[0:3], v[48:51], 0
    v_mfma_f32_16x16x32_bf16 v[84:87], a[16:19], v[48:51], 0
    v_mfma_f32_16x16x32_bf16 v[88:91], a[32:35], v[48:51], 0
    v_mfma_f32_16x16x32_bf16 v[92:95], a[48:51], v[48:51], 0
    v_cvt_pk_bf16_f32 v56, v32, v33
    v_cvt_pk_bf16_f32 v57, v34, v35
    v_cvt_pk_bf16_f32 v58, v36, v37
    v_cvt_pk_bf16_f32 v59, v38, v39
    v_mfma_f32_16x16x32_bf16 v[80:83], a[4:7], v[52:55], v[80:83]
    v_mfma_f32_16x16x32_bf16 v[84:87], a[20:23], v[52:55], v[84:87]
    v_mfma_f32_16x16x32_bf16 v[88:91], a[36:39], v[52:55], v[88:91]
    v_mfma_f32_16x16x32_bf16 v[92:95], a[52:55], v[52:55], v[92:95]
    v_cvt_pk_bf16_f32 v60, v40, v41
    v_cvt_pk_bf16_f32 v61, v42, v43
    v_cvt_pk_bf16_f32 v62, v44, v45
    v_cvt_pk_bf16_f32 v63, v46, v47
    v_mfma_f32_16x16x32_bf16 v[80:83], a[8:11], v[56:59], v[80:83]
    v_mfma_f32_16x16x32_bf16 v[84:87], a[24:27], v[56:59], v[84:87]
    v_mfma_f32_16x16x32_bf16 v[88:91], a[40:43], v[56:59], v[88:91]
    v_mfma_f32_16x16x32_bf16 v[92:95], a[56:59], v[56:59], v[92:95]
    v_mfma_f32_16x16x32_bf16 v[80:83], a[12:15], v[60:63], v[80:83]
    v_mfma_f32_16x16x32_bf16 v[84:87], a[28:31], v[60:63], v[84:87]
    v_mfma_f32_16x16x32_bf16 v[88:91], a[44:47], v[60:63], v[88:91]
    v_mfma_f32_16x16x32_bf16 v[92:95], a[60:63], v[60:63], v[92:95]
    s_nop 4
    v_fma_f32 v112, v80, s3, v112
    v_fma_f32 v113, v81, s3, v113
    v_fma_f32 v114, v82, s3, v114
    v_fma_f32 v115, v83, s3, v115
    v_cvt_pk_bf16_f32 v16, v112, v113
    v_cvt_pk_bf16_f32 v17, v114, v115
    buffer_store_dwordx2 v[16:17], v4, s[16:19], 0 offen offset:0
    v_fma_f32 v116, v84, s3, v116
    v_fma_f32 v117, v85, s3, v117
    v_fma_f32 v118, v86, s3, v118
    v_fma_f32 v119, v87, s3, v119
    v_cvt_pk_bf16_f32 v18, v116, v117
    v_cvt_pk_bf16_f32 v19, v118, v119
    buffer_store_dwordx2 v[18:19], v4, s[16:19], 0 offen offset:32
    v_fma_f32 v120, v88, s3, v120
    v_fma_f32 v121, v89, s3, v121
    v_fma_f32 v122, v90, s3, v122
    v_fma_f32 v123, v91, s3, v123
    v_cvt_pk_bf16_f32 v20, v120, v121
    v_cvt_pk_bf16_f32 v21, v122, v123
    buffer_store_dwordx2 v[20:21], v4, s[16:19], 0 offen offset:64
    v_fma_f32 v124, v92, s3, v124
    v_fma_f32 v125, v93, s3, v125
    v_fma_f32 v126, v94, s3, v126
    v_fma_f32 v127, v95, s3, v127
    v_cvt_pk_bf16_f32 v22, v124, v125
    v_cvt_pk_bf16_f32 v23, v126, v127
    buffer_store_dwordx2 v[22:23], v4, s[16:19], 0 offen offset:96
K_DONE:
K_END:
    s_endpgm
F_fl0:
    s_bitcmp1_b32 vcc_lo, 2
    s_cbranch_scc0 F_fl0_go
    s_cmp_gt_u32 s25, 2
    s_cselect_b32 s6, 10000, 0
    s_cselect_b32 s10, 640000, 0
    s_waitcnt lgkmcnt(0)
    s_add_u32 m0, s27, 4096
    s_nop 0
    buffer_load_dwordx4 v[140:141], s[8:11], 0 idxen offen lds
    s_add_u32 m0, s27, 0
    s_nop 0
    buffer_load_dwordx4 v[132:133], s[4:7], 0 idxen offen offset:0 lds
    buffer_load_dwordx4 v[134:135], s[4:7], 0 idxen offen offset:1024 lds
    buffer_load_dwordx4 v[136:137], s[4:7], 0 idxen offen offset:2048 lds
    buffer_load_dwordx4 v[138:139], s[4:7], 0 idxen offen offset:3072 lds
    s_branch F_flr0
F_fl0_go:
    s_and_b32 s30, vcc_lo, 0x33
    s_cbranch_scc0 F_fl0_u1
    s_and_b32 s30, vcc_lo, 0x3
    s_cbranch_scc0 F_fl0_0h1
    s_bitcmp1_b32 vcc_lo, 0
    s_cbranch_scc0 F_fl0_00p1
    v_readlane_b32 s30, v143, 0
    s_mov_b64 exec, s[66:67]
    s_bfe_u32 s30, s30, 0x60005
    s_mul_i32 s30, s30, 528
    v_add_u32 v157, s30, v156
    ds_write_b32 v157, v104 offset:0
    ds_write_b32 v157, v108 offset:128
    ds_write_b32 v157, v112 offset:256
    ds_write_b32 v157, v116 offset:384
    v_mul_f32 v104, 0, v104
    v_mul_f32 v108, 0, v108
    v_mul_f32 v112, 0, v112
    v_mul_f32 v116, 0, v116
    s_mov_b64 exec, -1
    s_and_b32 vcc_lo, vcc_lo, 0x330032
    s_cbranch_scc0 F_flr0
    s_branch F_fl0_go
F_fl0_00p1:
    v_readlane_b32 s30, v143, 1
    s_mov_b64 exec, s[66:67]
    s_bfe_u32 s30, s30, 0x60005
    s_mul_i32 s30, s30, 528
    v_add_u32 v157, s30, v156
    ds_write_b32 v157, v105 offset:0
    ds_write_b32 v157, v109 offset:128
    ds_write_b32 v157, v113 offset:256
    ds_write_b32 v157, v117 offset:384
    v_mul_f32 v105, 0, v105
    v_mul_f32 v109, 0, v109
    v_mul_f32 v113, 0, v113
    v_mul_f32 v117, 0, v117
    s_mov_b64 exec, -1
    s_and_b32 vcc_lo, vcc_lo, 0x330031
    s_cbranch_scc0 F_flr0
    s_branch F_fl0_go
F_fl0_0h1:
    s_bitcmp1_b32 vcc_lo, 4
    s_cbranch_scc0 F_fl0_01p1
    v_readlane_b32 s30, v143, 4
    s_mov_b64 exec, s[68:69]
    s_bfe_u32 s30, s30, 0x60005
    s_mul_i32 s30, s30, 528
    v_add_u32 v157, s30, v156
    ds_write_b32 v157, v104 offset:0
    ds_write_b32 v157, v108 offset:128
    ds_write_b32 v157, v112 offset:256
    ds_write_b32 v157, v116 offset:384
    v_mul_f32 v104, 0, v104
    v_mul_f32 v108, 0, v108
    v_mul_f32 v112, 0, v112
    v_mul_f32 v116, 0, v116
    s_mov_b64 exec, -1
    s_and_b32 vcc_lo, vcc_lo, 0x330023
    s_cbranch_scc0 F_flr0
    s_branch F_fl0_go
F_fl0_01p1:
    v_readlane_b32 s30, v143, 5
    s_mov_b64 exec, s[68:69]
    s_bfe_u32 s30, s30, 0x60005
    s_mul_i32 s30, s30, 528
    v_add_u32 v157, s30, v156
    ds_write_b32 v157, v105 offset:0
    ds_write_b32 v157, v109 offset:128
    ds_write_b32 v157, v113 offset:256
    ds_write_b32 v157, v117 offset:384
    v_mul_f32 v105, 0, v105
    v_mul_f32 v109, 0, v109
    v_mul_f32 v113, 0, v113
    v_mul_f32 v117, 0, v117
    s_mov_b64 exec, -1
    s_and_b32 vcc_lo, vcc_lo, 0x330013
    s_cbranch_scc0 F_flr0
    s_branch F_fl0_go
F_fl0_u1:
    s_and_b32 s30, vcc_lo, 0x330000
    s_cbranch_scc0 F_flr0
    s_and_b32 s30, vcc_lo, 0x30000
    s_cbranch_scc0 F_fl0_1h1
    s_bitcmp1_b32 vcc_lo, 16
    s_cbranch_scc0 F_fl0_10p1
    v_readlane_b32 s30, v143, 16
    s_mov_b64 exec, s[66:67]
    s_bfe_u32 s30, s30, 0x60005
    s_mul_i32 s30, s30, 528
    v_add_u32 v157, s30, v156
    ds_write_b32 v157, v106 offset:0
    ds_write_b32 v157, v110 offset:128
    ds_write_b32 v157, v114 offset:256
    ds_write_b32 v157, v118 offset:384
    v_mul_f32 v106, 0, v106
    v_mul_f32 v110, 0, v110
    v_mul_f32 v114, 0, v114
    v_mul_f32 v118, 0, v118
    s_mov_b64 exec, -1
    s_and_b32 vcc_lo, vcc_lo, 0x320033
    s_cbranch_scc0 F_flr0
    s_branch F_fl0_go
F_fl0_10p1:
    v_readlane_b32 s30, v143, 17
    s_mov_b64 exec, s[66:67]
    s_bfe_u32 s30, s30, 0x60005
    s_mul_i32 s30, s30, 528
    v_add_u32 v157, s30, v156
    ds_write_b32 v157, v107 offset:0
    ds_write_b32 v157, v111 offset:128
    ds_write_b32 v157, v115 offset:256
    ds_write_b32 v157, v119 offset:384
    v_mul_f32 v107, 0, v107
    v_mul_f32 v111, 0, v111
    v_mul_f32 v115, 0, v115
    v_mul_f32 v119, 0, v119
    s_mov_b64 exec, -1
    s_and_b32 vcc_lo, vcc_lo, 0x310033
    s_cbranch_scc0 F_flr0
    s_branch F_fl0_go
F_fl0_1h1:
    s_bitcmp1_b32 vcc_lo, 20
    s_cbranch_scc0 F_fl0_11p1
    v_readlane_b32 s30, v143, 20
    s_mov_b64 exec, s[68:69]
    s_bfe_u32 s30, s30, 0x60005
    s_mul_i32 s30, s30, 528
    v_add_u32 v157, s30, v156
    ds_write_b32 v157, v106 offset:0
    ds_write_b32 v157, v110 offset:128
    ds_write_b32 v157, v114 offset:256
    ds_write_b32 v157, v118 offset:384
    v_mul_f32 v106, 0, v106
    v_mul_f32 v110, 0, v110
    v_mul_f32 v114, 0, v114
    v_mul_f32 v118, 0, v118
    s_mov_b64 exec, -1
    s_and_b32 vcc_lo, vcc_lo, 0x230033
    s_cbranch_scc0 F_flr0
    s_branch F_fl0_go
F_fl0_11p1:
    v_readlane_b32 s30, v143, 21
    s_mov_b64 exec, s[68:69]
    s_bfe_u32 s30, s30, 0x60005
    s_mul_i32 s30, s30, 528
    v_add_u32 v157, s30, v156
    ds_write_b32 v157, v107 offset:0
    ds_write_b32 v157, v111 offset:128
    ds_write_b32 v157, v115 offset:256
    ds_write_b32 v157, v119 offset:384
    v_mul_f32 v107, 0, v107
    v_mul_f32 v111, 0, v111
    v_mul_f32 v115, 0, v115
    v_mul_f32 v119, 0, v119
    s_mov_b64 exec, -1
    s_and_b32 vcc_lo, vcc_lo, 0x130033
    s_cbranch_scc0 F_flr0
    s_branch F_fl0_go
F_fl1:
F_fl1_go:
    s_and_b32 s30, vcc_lo, 0x33
    s_cbranch_scc0 F_fl1_u1
    s_and_b32 s30, vcc_lo, 0x3
    s_cbranch_scc0 F_fl1_0h1
    s_bitcmp1_b32 vcc_lo, 0
    s_cbranch_scc0 F_fl1_00p1
    v_readlane_b32 s30, v142, 0
    s_mov_b64 exec, s[66:67]
    s_bfe_u32 s30, s30, 0x60005
    s_mul_i32 s30, s30, 528
    v_add_u32 v157, s30, v156
    ds_write_b32 v157, v104 offset:0
    ds_write_b32 v157, v108 offset:128
    ds_write_b32 v157, v112 offset:256
    ds_write_b32 v157, v116 offset:384
    v_mul_f32 v104, 0, v104
    v_mul_f32 v108, 0, v108
    v_mul_f32 v112, 0, v112
    v_mul_f32 v116, 0, v116
    s_mov_b64 exec, -1
    s_and_b32 vcc_lo, vcc_lo, 0x330032
    s_cbranch_scc0 F_flr1
    s_branch F_fl1_go
F_fl1_00p1:
    v_readlane_b32 s30, v142, 1
    s_mov_b64 exec, s[66:67]
    s_bfe_u32 s30, s30, 0x60005
    s_mul_i32 s30, s30, 528
    v_add_u32 v157, s30, v156
    ds_write_b32 v157, v105 offset:0
    ds_write_b32 v157, v109 offset:128
    ds_write_b32 v157, v113 offset:256
    ds_write_b32 v157, v117 offset:384
    v_mul_f32 v105, 0, v105
    v_mul_f32 v109, 0, v109
    v_mul_f32 v113, 0, v113
    v_mul_f32 v117, 0, v117
    s_mov_b64 exec, -1
    s_and_b32 vcc_lo, vcc_lo, 0x330031
    s_cbranch_scc0 F_flr1
    s_branch F_fl1_go
F_fl1_0h1:
    s_bitcmp1_b32 vcc_lo, 4
    s_cbranch_scc0 F_fl1_01p1
    v_readlane_b32 s30, v142, 4
    s_mov_b64 exec, s[68:69]
    s_bfe_u32 s30, s30, 0x60005
    s_mul_i32 s30, s30, 528
    v_add_u32 v157, s30, v156
    ds_write_b32 v157, v104 offset:0
    ds_write_b32 v157, v108 offset:128
    ds_write_b32 v157, v112 offset:256
    ds_write_b32 v157, v116 offset:384
    v_mul_f32 v104, 0, v104
    v_mul_f32 v108, 0, v108
    v_mul_f32 v112, 0, v112
    v_mul_f32 v116, 0, v116
    s_mov_b64 exec, -1
    s_and_b32 vcc_lo, vcc_lo, 0x330023
    s_cbranch_scc0 F_flr1
    s_branch F_fl1_go
F_fl1_01p1:
    v_readlane_b32 s30, v142, 5
    s_mov_b64 exec, s[68:69]
    s_bfe_u32 s30, s30, 0x60005
    s_mul_i32 s30, s30, 528
    v_add_u32 v157, s30, v156
    ds_write_b32 v157, v105 offset:0
    ds_write_b32 v157, v109 offset:128
    ds_write_b32 v157, v113 offset:256
    ds_write_b32 v157, v117 offset:384
    v_mul_f32 v105, 0, v105
    v_mul_f32 v109, 0, v109
    v_mul_f32 v113, 0, v113
    v_mul_f32 v117, 0, v117
    s_mov_b64 exec, -1
    s_and_b32 vcc_lo, vcc_lo, 0x330013
    s_cbranch_scc0 F_flr1
    s_branch F_fl1_go
F_fl1_u1:
    s_and_b32 s30, vcc_lo, 0x330000
    s_cbranch_scc0 F_flr1
    s_and_b32 s30, vcc_lo, 0x30000
    s_cbranch_scc0 F_fl1_1h1
    s_bitcmp1_b32 vcc_lo, 16
    s_cbranch_scc0 F_fl1_10p1
    v_readlane_b32 s30, v142, 16
    s_mov_b64 exec, s[66:67]
    s_bfe_u32 s30, s30, 0x60005
    s_mul_i32 s30, s30, 528
    v_add_u32 v157, s30, v156
    ds_write_b32 v157, v106 offset:0
    ds_write_b32 v157, v110 offset:128
    ds_write_b32 v157, v114 offset:256
    ds_write_b32 v157, v118 offset:384
    v_mul_f32 v106, 0, v106
    v_mul_f32 v110, 0, v110
    v_mul_f32 v114, 0, v114
    v_mul_f32 v118, 0, v118
    s_mov_b64 exec, -1
    s_and_b32 vcc_lo, vcc_lo, 0x320033
    s_cbranch_scc0 F_flr1
    s_branch F_fl1_go
F_fl1_10p1:
    v_readlane_b32 s30, v142, 17
    s_mov_b64 exec, s[66:67]
    s_bfe_u32 s30, s30, 0x60005
    s_mul_i32 s30, s30, 528
    v_add_u32 v157, s30, v156
    ds_write_b32 v157, v107 offset:0
    ds_write_b32 v157, v111 offset:128
    ds_write_b32 v157, v115 offset:256
    ds_write_b32 v157, v119 offset:384
    v_mul_f32 v107, 0, v107
    v_mul_f32 v111, 0, v111
    v_mul_f32 v115, 0, v115
    v_mul_f32 v119, 0, v119
    s_mov_b64 exec, -1
    s_and_b32 vcc_lo, vcc_lo, 0x310033
    s_cbranch_scc0 F_flr1
    s_branch F_fl1_go
F_fl1_1h1:
    s_bitcmp1_b32 vcc_lo, 20
    s_cbranch_scc0 F_fl1_11p1
    v_readlane_b32 s30, v142, 20
    s_mov_b64 exec, s[68:69]
    s_bfe_u32 s30, s30, 0x60005
    s_mul_i32 s30, s30, 528
    v_add_u32 v157, s30, v156
    ds_write_b32 v157, v106 offset:0
    ds_write_b32 v157, v110 offset:128
    ds_write_b32 v157, v114 offset:256
    ds_write_b32 v157, v118 offset:384
    v_mul_f32 v106, 0, v106
    v_mul_f32 v110, 0, v110
    v_mul_f32 v114, 0, v114
    v_mul_f32 v118, 0, v118
    s_mov_b64 exec, -1
    s_and_b32 vcc_lo, vcc_lo, 0x230033
    s_cbranch_scc0 F_flr1
    s_branch F_fl1_go
F_fl1_11p1:
    v_readlane_b32 s30, v142, 21
    s_mov_b64 exec, s[68:69]
    s_bfe_u32 s30, s30, 0x60005
    s_mul_i32 s30, s30, 528
    v_add_u32 v157, s30, v156
    ds_write_b32 v157, v107 offset:0
    ds_write_b32 v157, v111 offset:128
    ds_write_b32 v157, v115 offset:256
    ds_write_b32 v157, v119 offset:384
    v_mul_f32 v107, 0, v107
    v_mul_f32 v111, 0, v111
    v_mul_f32 v115, 0, v115
    v_mul_f32 v119, 0, v119
    s_mov_b64 exec, -1
    s_and_b32 vcc_lo, vcc_lo, 0x130033
    s_cbranch_scc0 F_flr1
    s_branch F_fl1_go
F_tlfl:
F_tlfl_go:
    s_and_b32 s30, vcc_lo, 0x33
    s_cbranch_scc0 F_tlfl_u1
    s_and_b32 s30, vcc_lo, 0x3
    s_cbranch_scc0 F_tlfl_0h1
    s_bitcmp1_b32 vcc_lo, 0
    s_cbranch_scc0 F_tlfl_00p1
    v_readlane_b32 s30, v143, 0
    s_mov_b64 exec, s[66:67]
    s_bfe_u32 s30, s30, 0x60005
    s_mul_i32 s30, s30, 528
    v_add_u32 v157, s30, v156
    ds_write_b32 v157, v104 offset:0
    ds_write_b32 v157, v108 offset:128
    ds_write_b32 v157, v112 offset:256
    ds_write_b32 v157, v116 offset:384
    v_mul_f32 v104, 0, v104
    v_mul_f32 v108, 0, v108
    v_mul_f32 v112, 0, v112
    v_mul_f32 v116, 0, v116
    s_mov_b64 exec, -1
    s_and_b32 vcc_lo, vcc_lo, 0x330032
    s_cbranch_scc0 F_tl_nofl
    s_branch F_tlfl_go
F_tlfl_00p1:
    v_readlane_b32 s30, v143, 1
    s_mov_b64 exec, s[66:67]
    s_bfe_u32 s30, s30, 0x60005
    s_mul_i32 s30, s30, 528
    v_add_u32 v157, s30, v156
    ds_write_b32 v157, v105 offset:0
    ds_write_b32 v157, v109 offset:128
    ds_write_b32 v157, v113 offset:256
    ds_write_b32 v157, v117 offset:384
    v_mul_f32 v105, 0, v105
    v_mul_f32 v109, 0, v109
    v_mul_f32 v113, 0, v113
    v_mul_f32 v117, 0, v117
    s_mov_b64 exec, -1
    s_and_b32 vcc_lo, vcc_lo, 0x330031
    s_cbranch_scc0 F_tl_nofl
    s_branch F_tlfl_go
F_tlfl_0h1:
    s_bitcmp1_b32 vcc_lo, 4
    s_cbranch_scc0 F_tlfl_01p1
    v_readlane_b32 s30, v143, 4
    s_mov_b64 exec, s[68:69]
    s_bfe_u32 s30, s30, 0x60005
    s_mul_i32 s30, s30, 528
    v_add_u32 v157, s30, v156
    ds_write_b32 v157, v104 offset:0
    ds_write_b32 v157, v108 offset:128
    ds_write_b32 v157, v112 offset:256
    ds_write_b32 v157, v116 offset:384
    v_mul_f32 v104, 0, v104
    v_mul_f32 v108, 0, v108
    v_mul_f32 v112, 0, v112
    v_mul_f32 v116, 0, v116
    s_mov_b64 exec, -1
    s_and_b32 vcc_lo, vcc_lo, 0x330023
    s_cbranch_scc0 F_tl_nofl
    s_branch F_tlfl_go
F_tlfl_01p1:
    v_readlane_b32 s30, v143, 5
    s_mov_b64 exec, s[68:69]
    s_bfe_u32 s30, s30, 0x60005
    s_mul_i32 s30, s30, 528
    v_add_u32 v157, s30, v156
    ds_write_b32 v157, v105 offset:0
    ds_write_b32 v157, v109 offset:128
    ds_write_b32 v157, v113 offset:256
    ds_write_b32 v157, v117 offset:384
    v_mul_f32 v105, 0, v105
    v_mul_f32 v109, 0, v109
    v_mul_f32 v113, 0, v113
    v_mul_f32 v117, 0, v117
    s_mov_b64 exec, -1
    s_and_b32 vcc_lo, vcc_lo, 0x330013
    s_cbranch_scc0 F_tl_nofl
    s_branch F_tlfl_go
F_tlfl_u1:
    s_and_b32 s30, vcc_lo, 0x330000
    s_cbranch_scc0 F_tl_nofl
    s_and_b32 s30, vcc_lo, 0x30000
    s_cbranch_scc0 F_tlfl_1h1
    s_bitcmp1_b32 vcc_lo, 16
    s_cbranch_scc0 F_tlfl_10p1
    v_readlane_b32 s30, v143, 16
    s_mov_b64 exec, s[66:67]
    s_bfe_u32 s30, s30, 0x60005
    s_mul_i32 s30, s30, 528
    v_add_u32 v157, s30, v156
    ds_write_b32 v157, v106 offset:0
    ds_write_b32 v157, v110 offset:128
    ds_write_b32 v157, v114 offset:256
    ds_write_b32 v157, v118 offset:384
    v_mul_f32 v106, 0, v106
    v_mul_f32 v110, 0, v110
    v_mul_f32 v114, 0, v114
    v_mul_f32 v118, 0, v118
    s_mov_b64 exec, -1
    s_and_b32 vcc_lo, vcc_lo, 0x320033
    s_cbranch_scc0 F_tl_nofl
    s_branch F_tlfl_go
F_tlfl_10p1:
    v_readlane_b32 s30, v143, 17
    s_mov_b64 exec, s[66:67]
    s_bfe_u32 s30, s30, 0x60005
    s_mul_i32 s30, s30, 528
    v_add_u32 v157, s30, v156
    ds_write_b32 v157, v107 offset:0
    ds_write_b32 v157, v111 offset:128
    ds_write_b32 v157, v115 offset:256
    ds_write_b32 v157, v119 offset:384
    v_mul_f32 v107, 0, v107
    v_mul_f32 v111, 0, v111
    v_mul_f32 v115, 0, v115
    v_mul_f32 v119, 0, v119
    s_mov_b64 exec, -1
    s_and_b32 vcc_lo, vcc_lo, 0x310033
    s_cbranch_scc0 F_tl_nofl
    s_branch F_tlfl_go
F_tlfl_1h1:
    s_bitcmp1_b32 vcc_lo, 20
    s_cbranch_scc0 F_tlfl_11p1
    v_readlane_b32 s30, v143, 20
    s_mov_b64 exec, s[68:69]
    s_bfe_u32 s30, s30, 0x60005
    s_mul_i32 s30, s30, 528
    v_add_u32 v157, s30, v156
    ds_write_b32 v157, v106 offset:0
    ds_write_b32 v157, v110 offset:128
    ds_write_b32 v157, v114 offset:256
    ds_write_b32 v157, v118 offset:384
    v_mul_f32 v106, 0, v106
    v_mul_f32 v110, 0, v110
    v_mul_f32 v114, 0, v114
    v_mul_f32 v118, 0, v118
    s_mov_b64 exec, -1
    s_and_b32 vcc_lo, vcc_lo, 0x230033
    s_cbranch_scc0 F_tl_nofl
    s_branch F_tlfl_go
F_tlfl_11p1:
    v_readlane_b32 s30, v143, 21
    s_mov_b64 exec, s[68:69]
    s_bfe_u32 s30, s30, 0x60005
    s_mul_i32 s30, s30, 528
    v_add_u32 v157, s30, v156
    ds_write_b32 v157, v107 offset:0
    ds_write_b32 v157, v111 offset:128
    ds_write_b32 v157, v115 offset:256
    ds_write_b32 v157, v119 offset:384
    v_mul_f32 v107, 0, v107
    v_mul_f32 v111, 0, v111
    v_mul_f32 v115, 0, v115
    v_mul_f32 v119, 0, v119
    s_mov_b64 exec, -1
    s_and_b32 vcc_lo, vcc_lo, 0x130033
    s_cbranch_scc0 F_tl_nofl
    s_branch F_tlfl_go
E_more:
    v_lshrrev_b32 v157, 3, v6
    v_and_b32 v158, 7, v6
    v_cmp_lt_u32 vcc, v6, v7
    v_mov_b32 v159, 2048
    v_mul_u32_u24 v157, 10368, v157
    v_mul_u32_u24 v158, 528, v158
    v_add_u32 v157, 79744, v157
    v_add_u32 v157, v157, v158
    v_cndmask_b32 v157, v159, v157, vcc
    v_add_u32 v9, v157, v2
    v_add_u32 v6, 1, v6
    ds_read_b128 v[48:51], v9 offset:0
    ds_read_b128 v[52:55], v9 offset:16
    ds_read_b128 v[56:59], v9 offset:32
    ds_read_b128 v[60:63], v9 offset:48
    ds_read_b128 v[64:67], v9 offset:64
    ds_read_b128 v[68:71], v9 offset:80
    ds_read_b128 v[72:75], v9 offset:96
    ds_read_b128 v[76:79], v9 offset:112
    v_cmp_lt_u32 vcc, v6, v7
    s_waitcnt lgkmcnt(0)
    v_pk_add_f32 v[16:17], v[16:17], v[48:49]
    v_pk_add_f32 v[18:19], v[18:19], v[50:51]
    v_pk_add_f32 v[20:21], v[20:21], v[52:53]
    v_pk_add_f32 v[22:23], v[22:23], v[54:55]
    v_pk_add_f32 v[24:25], v[24:25], v[56:57]
    v_pk_add_f32 v[26:27], v[26:27], v[58:59]
    v_pk_add_f32 v[28:29], v[28:29], v[60:61]
    v_pk_add_f32 v[30:31], v[30:31], v[62:63]
    v_pk_add_f32 v[32:33], v[32:33], v[64:65]
    v_pk_add_f32 v[34:35], v[34:35], v[66:67]
    v_pk_add_f32 v[36:37], v[36:37], v[68:69]
    v_pk_add_f32 v[38:39], v[38:39], v[70:71]
    v_pk_add_f32 v[40:41], v[40:41], v[72:73]
    v_pk_add_f32 v[42:43], v[42:43], v[74:75]
    v_pk_add_f32 v[44:45], v[44:45], v[76:77]
    v_pk_add_f32 v[46:47], v[46:47], v[78:79]
    s_cbranch_vccnz E_more
    s_branch E_sum
E_idle:
    s_waitcnt lgkmcnt(0)
    v_cmp_ne_u32 vcc, 0, v5
    s_cbranch_vccnz K_SLOW
    s_branch K_DONE
F_sa_more:
    s_waitcnt vmcnt(6)
    v_and_b32_sdwa v42, v26, v4 dst_sel:DWORD dst_unused:UNUSED_PAD src0_sel:BYTE_3 src1_sel:DWORD
    v_and_b32_sdwa v43, v27, v4 dst_sel:DWORD dst_unused:UNUSED_PAD src0_sel:BYTE_3 src1_sel:DWORD
    v_and_b32_sdwa v44, v28, v4 dst_sel:DWORD dst_unused:UNUSED_PAD src0_sel:BYTE_3 src1_sel:DWORD
    v_and_b32_sdwa v45, v29, v4 dst_sel:DWORD dst_unused:UNUSED_PAD src0_sel:BYTE_3 src1_sel:DWORD
    v_and_b32_sdwa v46, v30, v4 dst_sel:DWORD dst_unused:UNUSED_PAD src0_sel:BYTE_3 src1_sel:DWORD
    v_and_b32_sdwa v47, v31, v4 dst_sel:DWORD dst_unused:UNUSED_PAD src0_sel:BYTE_3 src1_sel:DWORD
    s_mov_b64 exec, s[52:53]
    ds_add_rtn_u32 v58, v42, v5 offset:1536
    s_mov_b64 exec, s[54:55]
    ds_add_rtn_u32 v59, v43, v5 offset:1536
    s_mov_b64 exec, s[56:57]
    ds_add_rtn_u32 v60, v44, v5 offset:1536
    s_mov_b64 exec, s[58:59]
    ds_add_rtn_u32 v61, v45, v5 offset:1536
    s_mov_b64 exec, s[60:61]
    ds_add_rtn_u32 v62, v46, v5 offset:1536
    s_mov_b64 exec, s[62:63]
    ds_add_rtn_u32 v63, v47, v5 offset:1536
    s_mov_b64 exec, -1
    v_bfe_u32 v85, v26, 14, 12
    v_lshlrev_b32 v84, 19, v42
    v_add_u32 v85, v85, v11
    v_and_or_b32 v84, v26, s30, v84
    v_bfe_u32 v87, v27, 14, 12
    v_lshlrev_b32 v86, 19, v43
    v_add_u32 v87, v87, v13
    v_and_or_b32 v86, v27, s30, v86
    v_bfe_u32 v89, v28, 14, 12
    v_lshlrev_b32 v88, 19, v44
    v_add_u32 v89, v89, v11
    v_and_or_b32 v88, v28, s30, v88
    v_bfe_u32 v91, v29, 14, 12
    v_lshlrev_b32 v90, 19, v45
    v_add_u32 v91, v91, v13
    v_and_or_b32 v90, v29, s30, v90
    v_bfe_u32 v93, v30, 14, 12
    v_lshlrev_b32 v92, 19, v46
    v_add_u32 v93, v93, v11
    v_and_or_b32 v92, v30, s30, v92
    v_bfe_u32 v95, v31, 14, 12
    v_lshlrev_b32 v94, 19, v47
    v_add_u32 v95, v95, v13
    v_and_or_b32 v94, v31, s30, v94
    s_branch F_sa_done
F_sb_more:
    ds_read_b32 v96, v42 offset:1792
    ds_read_b32 v97, v43 offset:1792
    ds_read_b32 v98, v44 offset:1792
    ds_read_b32 v99, v45 offset:1792
    ds_read_b32 v100, v46 offset:1792
    ds_read_b32 v101, v47 offset:1792
    s_waitcnt lgkmcnt(5)
    v_add_u32 v58, v58, v96
    s_mov_b64 exec, s[52:53]
    ds_write_b64 v58, v[84:85] offset:3200
    s_mov_b64 exec, -1
    s_waitcnt lgkmcnt(5)
    v_add_u32 v59, v59, v97
    s_mov_b64 exec, s[54:55]
    ds_write_b64 v59, v[86:87] offset:3200
    s_mov_b64 exec, -1
    s_waitcnt lgkmcnt(5)
    v_add_u32 v60, v60, v98
    s_mov_b64 exec, s[56:57]
    ds_write_b64 v60, v[88:89] offset:3200
    s_mov_b64 exec, -1
    s_waitcnt lgkmcnt(5)
    v_add_u32 v61, v61, v99
    s_mov_b64 exec, s[58:59]
    ds_write_b64 v61, v[90:91] offset:3200
    s_mov_b64 exec, -1
    s_waitcnt lgkmcnt(5)
    v_add_u32 v62, v62, v100
    s_mov_b64 exec, s[60:61]
    ds_write_b64 v62, v[92:93] offset:3200
    s_mov_b64 exec, -1
    s_waitcnt lgkmcnt(5)
    v_add_u32 v63, v63, v101
    s_mov_b64 exec, s[62:63]
    ds_write_b64 v63, v[94:95] offset:3200
    s_mov_b64 exec, -1
    s_branch F_sb_done
F_q16:
    s_cmp_lt_i32 s101, 16
    s_cselect_b32 s30, 0, 0x7f800000
    v_max_f32 v164, s30, v164
    s_lshr_b32 s30, s76, 4
    s_min_u32 s30, s30, 2
    s_lshl_b32 s30, s30, 5
    s_add_u32 s31, s30, 32
    s_min_u32 s31, s31, 64
    v_and_b32 v2, 31, v1
    v_mul_u32_u24 v2, 112, v2
    v_lshrrev_b32 v4, 0, v155
    v_add3_u32 v3, v2, v4, s31
    v_add3_u32 v2, v2, v4, s30
    ds_read_b128 v[88:91], v2 offset:49024
    ds_read_b128 v[32:35], v3 offset:49024
    ds_read_b128 v[92:95], v2 offset:52608
    ds_read_b128 v[36:39], v3 offset:52608
    ds_read_b128 v[96:99], v2 offset:56192
    ds_read_b128 v[40:43], v3 offset:56192
    ds_read_b128 v[100:103], v2 offset:59776
    ds_read_b128 v[44:47], v3 offset:59776
    s_and_b32 s76, s76, 15
    v_lshrrev_b32 v3, 1, v4
    v_sub_u32 v3, s76, v3
    v_mov_b32 v4, 0xffff
    v_cmp_lt_i32 s[78:79], 0, v3
    v_cmp_lt_i32 s[80:81], 1, v3
    s_nop 0
    v_cndmask_b32 v48, 0, v4, s[78:79]
    v_cndmask_b32 v48, v48, -1, s[80:81]
    v_cmp_lt_i32 s[78:79], 2, v3
    v_cmp_lt_i32 s[80:81], 3, v3
    s_nop 0
    v_cndmask_b32 v49, 0, v4, s[78:79]
    v_cndmask_b32 v49, v49, -1, s[80:81]
    v_cmp_lt_i32 s[78:79], 4, v3
    v_cmp_lt_i32 s[80:81], 5, v3
    s_nop 0
    v_cndmask_b32 v50, 0, v4, s[78:79]
    v_cndmask_b32 v50, v50, -1, s[80:81]
    v_cmp_lt_i32 s[78:79], 6, v3
    v_cmp_lt_i32 s[80:81], 7, v3
    s_nop 0
    v_cndmask_b32 v51, 0, v4, s[78:79]
    v_cndmask_b32 v51, v51, -1, s[80:81]
    s_waitcnt lgkmcnt(0)
    v_bfi_b32 v88, v48, v32, v88
    v_bfi_b32 v89, v49, v33, v89
    v_bfi_b32 v90, v50, v34, v90
    v_bfi_b32 v91, v51, v35, v91
    v_bfi_b32 v92, v48, v36, v92
    v_bfi_b32 v93, v49, v37, v93
    v_bfi_b32 v94, v50, v38, v94
    v_bfi_b32 v95, v51, v39, v95
    v_bfi_b32 v96, v48, v40, v96
    v_bfi_b32 v97, v49, v41, v97
    v_bfi_b32 v98, v50, v42, v98
    v_bfi_b32 v99, v51, v43, v99
    v_bfi_b32 v100, v48, v44, v100
    v_bfi_b32 v101, v49, v45, v101
    v_bfi_b32 v102, v50, v46, v102
    v_bfi_b32 v103, v51, v47, v103
    s_branch F_qdone
G_start:
    ds_read_b128 v[64:67], v150 offset:0
    ds_read_b128 v[68:71], v151 offset:0
    ds_read_b128 v[72:75], v152 offset:0
    ds_read_b128 v[76:79], v153 offset:0
    ds_read_b128 v[80:83], v154 offset:0
    ds_read_b128 v[84:87], v144 offset:0
    s_waitcnt lgkmcnt(5)
    v_mfma_f32_32x32x16_bf16 v[16:31], v[64:67], a[0:3], 0
    s_waitcnt lgkmcnt(4)
    v_mfma_f32_32x32x16_bf16 v[16:31], v[68:71], a[16:19], v[16:31]
    s_waitcnt lgkmcnt(3)
    v_mfma_f32_32x32x16_bf16 v[16:31], v[72:75], a[32:35], v[16:31]
    s_waitcnt lgkmcnt(2)
    v_mfma_f32_32x32x16_bf16 v[16:31], v[76:79], a[48:51], v[16:31]
    s_waitcnt lgkmcnt(1)
    v_mfma_f32_32x32x16_bf16 v[16:31], v[80:83], a[64:67], v[16:31]
    s_waitcnt lgkmcnt(0)
    v_mfma_f32_32x32x16_bf16 v[16:31], v[84:87], v[88:91], v[16:31]
    s_cmp_lt_u32 s24, 4
    s_cbranch_scc1 G_a2
    s_add_u32 m0, s27, 9216
    s_nop 0
    buffer_load_dwordx4 v[140:141], s[8:11], 0 idxen offen lds
    s_add_u32 m0, s27, 5120
    s_nop 0
    buffer_load_dwordx4 v[132:133], s[4:7], 0 idxen offen offset:0 lds
    buffer_load_dwordx4 v[134:135], s[4:7], 0 idxen offen offset:1024 lds
    buffer_load_dwordx4 v[136:137], s[4:7], 0 idxen offen offset:2048 lds
    buffer_load_dwordx4 v[138:139], s[4:7], 0 idxen offen offset:3072 lds
G_a2:
    s_nop 5
    ds_read_b32 v140, v148 offset:3268
    ds_read_u16 v132, v146 offset:3264
    ds_read_u16 v134, v146 offset:3280
    ds_read_u16 v136, v147 offset:3264
    ds_read_u16 v138, v147 offset:3280
    s_cmp_eq_u32 s25, 0
    s_cbranch_scc1 F_tail1
G_it0:
    v_mfma_f32_32x32x16_bf16 v[32:47], v[64:67], a[4:7], 0
    v_rcp_f32 v128, v124
    v_rcp_f32 v129, v125
    v_rcp_f32 v130, v126
    v_mfma_f32_32x32x16_bf16 v[32:47], v[68:71], a[20:23], v[32:47]
    v_rcp_f32 v131, v127
    v_exp_f32 v48, v16
    v_exp_f32 v49, v17
    v_mfma_f32_32x32x16_bf16 v[32:47], v[72:75], a[36:39], v[32:47]
    v_exp_f32 v56, v24
    v_exp_f32 v57, v25
    v_exp_f32 v50, v18
    v_mfma_f32_32x32x16_bf16 v[32:47], v[76:79], a[52:55], v[32:47]
    v_exp_f32 v51, v19
    v_exp_f32 v58, v26
    v_exp_f32 v59, v27
    v_mfma_f32_32x32x16_bf16 v[32:47], v[80:83], a[68:71], v[32:47]
    v_exp_f32 v52, v20
    v_exp_f32 v53, v21
    v_exp_f32 v60, v28
    v_mfma_f32_32x32x16_bf16 v[32:47], v[84:87], v[92:95], v[32:47]
    v_exp_f32 v61, v29
    v_exp_f32 v54, v22
    v_exp_f32 v55, v23
    v_exp_f32 v62, v30
    v_exp_f32 v63, v31
    v_cmp_gt_i16 vcc, 0, v143
    v_pk_fma_f32 v[164:165], v[124:125], v[126:127], v[164:165]
    v_pk_fma_f32 v[116:117], v[120:121], v[128:129], v[116:117]
    v_pk_fma_f32 v[118:119], v[122:123], v[130:131], v[118:119]
    s_cbranch_vccnz G_fl0
G_flr0:
    v_pk_add_f32 v[124:125], v[48:49], 1.0 op_sel_hi:[1,0]
    v_pk_add_f32 v[126:127], v[56:57], 1.0 op_sel_hi:[1,0]
    ds_read_u16 v143, v149 offset:3234
    v_pk_fma_f32 v[120:121], v[16:17], v[50:51], v[16:17]
    v_pk_fma_f32 v[122:123], v[24:25], v[58:59], v[24:25]
    ds_read_b32 v140, v148 offset:3300
    v_pk_fma_f32 v[120:121], v[18:19], v[124:125], v[120:121]
    v_pk_fma_f32 v[122:123], v[26:27], v[126:127], v[122:123]
    ds_read_u16 v132, v146 offset:3296
    v_pk_fma_f32 v[124:125], v[124:125], v[50:51], v[124:125]
    v_pk_fma_f32 v[126:127], v[126:127], v[58:59], v[126:127]
    ds_read_u16 v134, v146 offset:3312
    v_pk_fma_f32 v[120:121], v[120:121], v[52:53], v[120:121]
    v_pk_fma_f32 v[122:123], v[122:123], v[60:61], v[122:123]
    ds_read_u16 v136, v147 offset:3296
    v_pk_fma_f32 v[120:121], v[20:21], v[124:125], v[120:121]
    v_pk_fma_f32 v[122:123], v[28:29], v[126:127], v[122:123]
    ds_read_u16 v138, v147 offset:3312
    v_pk_fma_f32 v[124:125], v[124:125], v[52:53], v[124:125]
    v_pk_fma_f32 v[126:127], v[126:127], v[60:61], v[126:127]
    v_pk_fma_f32 v[120:121], v[120:121], v[54:55], v[120:121]
    v_pk_fma_f32 v[122:123], v[122:123], v[62:63], v[122:123]
    v_pk_fma_f32 v[120:121], v[22:23], v[124:125], v[120:121]
    v_pk_fma_f32 v[122:123], v[30:31], v[126:127], v[122:123]
    v_pk_fma_f32 v[124:125], v[124:125], v[54:55], v[124:125]
    v_pk_fma_f32 v[126:127], v[126:127], v[62:63], v[126:127]
    v_mfma_f32_32x32x16_bf16 v[16:31], v[64:67], a[8:11], 0
    v_rcp_f32 v128, v124
    v_rcp_f32 v129, v125
    v_rcp_f32 v130, v126
    v_mfma_f32_32x32x16_bf16 v[16:31], v[68:71], a[24:27], v[16:31]
    v_rcp_f32 v131, v127
    v_exp_f32 v48, v32
    v_exp_f32 v49, v33
    v_mfma_f32_32x32x16_bf16 v[16:31], v[72:75], a[40:43], v[16:31]
    v_exp_f32 v56, v40
    v_exp_f32 v57, v41
    v_exp_f32 v50, v34
    v_mfma_f32_32x32x16_bf16 v[16:31], v[76:79], a[56:59], v[16:31]
    v_exp_f32 v51, v35
    v_exp_f32 v58, v42
    v_exp_f32 v59, v43
    v_mfma_f32_32x32x16_bf16 v[16:31], v[80:83], a[72:75], v[16:31]
    v_exp_f32 v52, v36
    v_exp_f32 v53, v37
    v_exp_f32 v60, v44
    v_mfma_f32_32x32x16_bf16 v[16:31], v[84:87], v[96:99], v[16:31]
    v_exp_f32 v61, v45
    v_exp_f32 v54, v38
    v_exp_f32 v55, v39
    v_exp_f32 v62, v46
    v_exp_f32 v63, v47
    v_pk_fma_f32 v[164:165], v[124:125], v[126:127], v[164:165]
    v_pk_fma_f32 v[104:105], v[120:121], v[128:129], v[104:105]
    v_pk_fma_f32 v[106:107], v[122:123], v[130:131], v[106:107]
    v_pk_add_f32 v[124:125], v[48:49], 1.0 op_sel_hi:[1,0]
    v_pk_add_f32 v[126:127], v[56:57], 1.0 op_sel_hi:[1,0]
    v_pk_fma_f32 v[120:121], v[32:33], v[50:51], v[32:33]
    v_pk_fma_f32 v[122:123], v[40:41], v[58:59], v[40:41]
    v_pk_fma_f32 v[120:121], v[34:35], v[124:125], v[120:121]
    v_pk_fma_f32 v[122:123], v[42:43], v[126:127], v[122:123]
    v_pk_fma_f32 v[124:125], v[124:125], v[50:51], v[124:125]
    v_pk_fma_f32 v[126:127], v[126:127], v[58:59], v[126:127]
    v_pk_fma_f32 v[120:121], v[120:121], v[52:53], v[120:121]
    v_pk_fma_f32 v[122:123], v[122:123], v[60:61], v[122:123]
    v_pk_fma_f32 v[120:121], v[36:37], v[124:125], v[120:121]
    v_pk_fma_f32 v[122:123], v[44:45], v[126:127], v[122:123]
    v_pk_fma_f32 v[124:125], v[124:125], v[52:53], v[124:125]
    v_pk_fma_f32 v[126:127], v[126:127], v[60:61], v[126:127]
    v_pk_fma_f32 v[120:121], v[120:121], v[54:55], v[120:121]
    v_pk_fma_f32 v[122:123], v[122:123], v[62:63], v[122:123]
    v_pk_fma_f32 v[120:121], v[38:39], v[124:125], v[120:121]
    v_pk_fma_f32 v[122:123], v[46:47], v[126:127], v[122:123]
    v_pk_fma_f32 v[124:125], v[124:125], v[54:55], v[124:125]
    v_pk_fma_f32 v[126:127], v[126:127], v[62:63], v[126:127]
    v_mfma_f32_32x32x16_bf16 v[32:47], v[64:67], a[12:15], 0
    v_rcp_f32 v128, v124
    v_rcp_f32 v129, v125
    v_rcp_f32 v130, v126
    v_mfma_f32_32x32x16_bf16 v[32:47], v[68:71], a[28:31], v[32:47]
    v_rcp_f32 v131, v127
    v_exp_f32 v48, v16
    v_exp_f32 v49, v17
    v_mfma_f32_32x32x16_bf16 v[32:47], v[72:75], a[44:47], v[32:47]
    v_exp_f32 v56, v24
    v_exp_f32 v57, v25
    v_exp_f32 v50, v18
    v_mfma_f32_32x32x16_bf16 v[32:47], v[76:79], a[60:63], v[32:47]
    v_exp_f32 v51, v19
    v_exp_f32 v58, v26
    v_exp_f32 v59, v27
    v_mfma_f32_32x32x16_bf16 v[32:47], v[80:83], a[76:79], v[32:47]
    v_exp_f32 v52, v20
    v_exp_f32 v53, v21
    v_exp_f32 v60, v28
    v_mfma_f32_32x32x16_bf16 v[32:47], v[84:87], v[100:103], v[32:47]
    v_exp_f32 v61, v29
    v_exp_f32 v54, v22
    v_exp_f32 v55, v23
    v_exp_f32 v62, v30
    v_exp_f32 v63, v31
    s_sub_u32 s26, s26, 1
    s_cbranch_scc1 G_last0
    s_waitcnt vmcnt(5) lgkmcnt(0)
    v_and_or_b32 v144, v143, s64, v155
    v_pk_fma_f32 v[164:165], v[124:125], v[126:127], v[164:165]
    ds_read_b128 v[64:67], v150 offset:5120
    v_pk_fma_f32 v[108:109], v[120:121], v[128:129], v[108:109]
    ds_read_b128 v[68:71], v151 offset:5120
    v_pk_fma_f32 v[110:111], v[122:123], v[130:131], v[110:111]
    ds_read_b128 v[72:75], v152 offset:5120
    v_pk_add_f32 v[124:125], v[48:49], 1.0 op_sel_hi:[1,0]
    ds_read_b128 v[76:79], v153 offset:5120
    v_pk_add_f32 v[126:127], v[56:57], 1.0 op_sel_hi:[1,0]
    ds_read_b128 v[80:83], v154 offset:5120
    v_pk_fma_f32 v[120:121], v[16:17], v[50:51], v[16:17]
    ds_read_b128 v[84:87], v144 offset:0
    v_pk_fma_f32 v[122:123], v[24:25], v[58:59], v[24:25]
    v_pk_fma_f32 v[120:121], v[18:19], v[124:125], v[120:121]
    v_pk_fma_f32 v[122:123], v[26:27], v[126:127], v[122:123]
    v_pk_fma_f32 v[124:125], v[124:125], v[50:51], v[124:125]
    v_pk_fma_f32 v[126:127], v[126:127], v[58:59], v[126:127]
    v_pk_fma_f32 v[120:121], v[120:121], v[52:53], v[120:121]
    v_pk_fma_f32 v[122:123], v[122:123], v[60:61], v[122:123]
    v_pk_fma_f32 v[120:121], v[20:21], v[124:125], v[120:121]
    v_pk_fma_f32 v[122:123], v[28:29], v[126:127], v[122:123]
    v_pk_fma_f32 v[124:125], v[124:125], v[52:53], v[124:125]
    v_pk_fma_f32 v[126:127], v[126:127], v[60:61], v[126:127]
    v_pk_fma_f32 v[120:121], v[120:121], v[54:55], v[120:121]
    v_pk_fma_f32 v[122:123], v[122:123], v[62:63], v[122:123]
    v_pk_fma_f32 v[120:121], v[22:23], v[124:125], v[120:121]
    v_pk_fma_f32 v[122:123], v[30:31], v[126:127], v[122:123]
    v_pk_fma_f32 v[124:125], v[124:125], v[54:55], v[124:125]
    v_pk_fma_f32 v[126:127], v[126:127], v[62:63], v[126:127]
    s_waitcnt lgkmcnt(0)
    v_mfma_f32_32x32x16_bf16 v[16:31], v[64:67], a[0:3], 0
    v_rcp_f32 v128, v124
    v_rcp_f32 v129, v125
    v_rcp_f32 v130, v126
    v_mfma_f32_32x32x16_bf16 v[16:31], v[68:71], a[16:19], v[16:31]
    v_rcp_f32 v131, v127
    v_exp_f32 v48, v32
    v_exp_f32 v49, v33
    v_mfma_f32_32x32x16_bf16 v[16:31], v[72:75], a[32:35], v[16:31]
    v_exp_f32 v56, v40
    v_exp_f32 v57, v41
    v_exp_f32 v50, v34
    v_mfma_f32_32x32x16_bf16 v[16:31], v[76:79], a[48:51], v[16:31]
    v_exp_f32 v51, v35
    v_exp_f32 v58, v42
    v_exp_f32 v59, v43
    v_mfma_f32_32x32x16_bf16 v[16:31], v[80:83], a[64:67], v[16:31]
    v_exp_f32 v52, v36
    v_exp_f32 v53, v37
    v_exp_f32 v60, v44
    v_mfma_f32_32x32x16_bf16 v[16:31], v[84:87], v[88:91], v[16:31]
    v_exp_f32 v61, v45
    v_exp_f32 v54, v38
    v_exp_f32 v55, v39
    v_exp_f32 v62, v46
    v_exp_f32 v63, v47
    v_pk_fma_f32 v[164:165], v[124:125], v[126:127], v[164:165]
    v_pk_fma_f32 v[112:113], v[120:121], v[128:129], v[112:113]
    s_cmp_gt_u32 s26, 1
    v_pk_fma_f32 v[114:115], v[122:123], v[130:131], v[114:115]
    v_pk_add_f32 v[124:125], v[48:49], 1.0 op_sel_hi:[1,0]
    s_cselect_b32 s6, 10000, 0
    v_pk_add_f32 v[126:127], v[56:57], 1.0 op_sel_hi:[1,0]
    v_pk_fma_f32 v[120:121], v[32:33], v[50:51], v[32:33]
    s_cselect_b32 s10, 640000, 0
    v_pk_fma_f32 v[122:123], v[40:41], v[58:59], v[40:41]
    v_pk_fma_f32 v[120:121], v[34:35], v[124:125], v[120:121]
    s_add_u32 m0, s27, 9216
    v_pk_fma_f32 v[122:123], v[42:43], v[126:127], v[122:123]
    v_pk_fma_f32 v[124:125], v[124:125], v[50:51], v[124:125]
    buffer_load_dwordx4 v[140:141], s[8:11], 0 idxen offen lds
    v_pk_fma_f32 v[126:127], v[126:127], v[58:59], v[126:127]
    v_pk_fma_f32 v[120:121], v[120:121], v[52:53], v[120:121]
    s_add_u32 m0, s27, 5120
    v_pk_fma_f32 v[122:123], v[122:123], v[60:61], v[122:123]
    v_pk_fma_f32 v[120:121], v[36:37], v[124:125], v[120:121]
    buffer_load_dwordx4 v[132:133], s[4:7], 0 idxen offen offset:0 lds
    v_pk_fma_f32 v[122:123], v[44:45], v[126:127], v[122:123]
    v_pk_fma_f32 v[124:125], v[124:125], v[52:53], v[124:125]
    buffer_load_dwordx4 v[134:135], s[4:7], 0 idxen offen offset:1024 lds
    v_pk_fma_f32 v[126:127], v[126:127], v[60:61], v[126:127]
    v_pk_fma_f32 v[120:121], v[120:121], v[54:55], v[120:121]
    buffer_load_dwordx4 v[136:137], s[4:7], 0 idxen offen offset:2048 lds
    v_pk_fma_f32 v[122:123], v[122:123], v[62:63], v[122:123]
    v_pk_fma_f32 v[120:121], v[38:39], v[124:125], v[120:121]
    buffer_load_dwordx4 v[138:139], s[4:7], 0 idxen offen offset:3072 lds
    v_pk_fma_f32 v[122:123], v[46:47], v[126:127], v[122:123]
    v_pk_fma_f32 v[124:125], v[124:125], v[54:55], v[124:125]
    v_pk_fma_f32 v[126:127], v[126:127], v[62:63], v[126:127]
G_it1:
    v_mfma_f32_32x32x16_bf16 v[32:47], v[64:67], a[4:7], 0
    v_rcp_f32 v128, v124
    v_rcp_f32 v129, v125
    v_rcp_f32 v130, v126
    v_mfma_f32_32x32x16_bf16 v[32:47], v[68:71], a[20:23], v[32:47]
    v_rcp_f32 v131, v127
    v_exp_f32 v48, v16
    v_exp_f32 v49, v17
    v_mfma_f32_32x32x16_bf16 v[32:47], v[72:75], a[36:39], v[32:47]
    v_exp_f32 v56, v24
    v_exp_f32 v57, v25
    v_exp_f32 v50, v18
    v_mfma_f32_32x32x16_bf16 v[32:47], v[76:79], a[52:55], v[32:47]
    v_exp_f32 v51, v19
    v_exp_f32 v58, v26
    v_exp_f32 v59, v27
    v_mfma_f32_32x32x16_bf16 v[32:47], v[80:83], a[68:71], v[32:47]
    v_exp_f32 v52, v20
    v_exp_f32 v53, v21
    v_exp_f32 v60, v28
    v_mfma_f32_32x32x16_bf16 v[32:47], v[84:87], v[92:95], v[32:47]
    v_exp_f32 v61, v29
    v_exp_f32 v54, v22
    v_exp_f32 v55, v23
    v_exp_f32 v62, v30
    v_exp_f32 v63, v31
    v_cmp_gt_i16 vcc, 0, v142
    v_pk_fma_f32 v[164:165], v[124:125], v[126:127], v[164:165]
    v_pk_fma_f32 v[116:117], v[120:121], v[128:129], v[116:117]
    v_pk_fma_f32 v[118:119], v[122:123], v[130:131], v[118:119]
    s_cbranch_vccnz G_fl1
G_flr1:
    v_pk_add_f32 v[124:125], v[48:49], 1.0 op_sel_hi:[1,0]
    v_pk_add_f32 v[126:127], v[56:57], 1.0 op_sel_hi:[1,0]
    ds_read_u16 v142, v149 offset:3266
    v_pk_fma_f32 v[120:121], v[16:17], v[50:51], v[16:17]
    v_pk_fma_f32 v[122:123], v[24:25], v[58:59], v[24:25]
    ds_read_b32 v140, v148 offset:3332
    v_pk_fma_f32 v[120:121], v[18:19], v[124:125], v[120:121]
    v_pk_fma_f32 v[122:123], v[26:27], v[126:127], v[122:123]
    ds_read_u16 v132, v146 offset:3328
    v_pk_fma_f32 v[124:125], v[124:125], v[50:51], v[124:125]
    v_pk_fma_f32 v[126:127], v[126:127], v[58:59], v[126:127]
    ds_read_u16 v134, v146 offset:3344
    v_pk_fma_f32 v[120:121], v[120:121], v[52:53], v[120:121]
    v_pk_fma_f32 v[122:123], v[122:123], v[60:61], v[122:123]
    ds_read_u16 v136, v147 offset:3328
    v_pk_fma_f32 v[120:121], v[20:21], v[124:125], v[120:121]
    v_pk_fma_f32 v[122:123], v[28:29], v[126:127], v[122:123]
    ds_read_u16 v138, v147 offset:3344
    v_pk_fma_f32 v[124:125], v[124:125], v[52:53], v[124:125]
    v_pk_fma_f32 v[126:127], v[126:127], v[60:61], v[126:127]
    v_pk_fma_f32 v[120:121], v[120:121], v[54:55], v[120:121]
    v_pk_fma_f32 v[122:123], v[122:123], v[62:63], v[122:123]
    v_pk_fma_f32 v[120:121], v[22:23], v[124:125], v[120:121]
    v_pk_fma_f32 v[122:123], v[30:31], v[126:127], v[122:123]
    v_pk_fma_f32 v[124:125], v[124:125], v[54:55], v[124:125]
    v_pk_fma_f32 v[126:127], v[126:127], v[62:63], v[126:127]
    v_mfma_f32_32x32x16_bf16 v[16:31], v[64:67], a[8:11], 0
    v_rcp_f32 v128, v124
    v_rcp_f32 v129, v125
    v_rcp_f32 v130, v126
    v_mfma_f32_32x32x16_bf16 v[16:31], v[68:71], a[24:27], v[16:31]
    v_rcp_f32 v131, v127
    v_exp_f32 v48, v32
    v_exp_f32 v49, v33
    v_mfma_f32_32x32x16_bf16 v[16:31], v[72:75], a[40:43], v[16:31]
    v_exp_f32 v56, v40
    v_exp_f32 v57, v41
    v_exp_f32 v50, v34
    v_mfma_f32_32x32x16_bf16 v[16:31], v[76:79], a[56:59], v[16:31]
    v_exp_f32 v51, v35
    v_exp_f32 v58, v42
    v_exp_f32 v59, v43
    v_mfma_f32_32x32x16_bf16 v[16:31], v[80:83], a[72:75], v[16:31]
    v_exp_f32 v52, v36
    v_exp_f32 v53, v37
    v_exp_f32 v60, v44
    v_mfma_f32_32x32x16_bf16 v[16:31], v[84:87], v[96:99], v[16:31]
    v_exp_f32 v61, v45
    v_exp_f32 v54, v38
    v_exp_f32 v55, v39
    v_exp_f32 v62, v46
    v_exp_f32 v63, v47
    v_pk_fma_f32 v[164:165], v[124:125], v[126:127], v[164:165]
    v_pk_fma_f32 v[104:105], v[120:121], v[128:129], v[104:105]
    v_pk_fma_f32 v[106:107], v[122:123], v[130:131], v[106:107]
    v_pk_add_f32 v[124:125], v[48:49], 1.0 op_sel_hi:[1,0]
    v_pk_add_f32 v[126:127], v[56:57], 1.0 op_sel_hi:[1,0]
    v_pk_fma_f32 v[120:121], v[32:33], v[50:51], v[32:33]
    v_pk_fma_f32 v[122:123], v[40:41], v[58:59], v[40:41]
    v_pk_fma_f32 v[120:121], v[34:35], v[124:125], v[120:121]
    v_pk_fma_f32 v[122:123], v[42:43], v[126:127], v[122:123]
    v_pk_fma_f32 v[124:125], v[124:125], v[50:51], v[124:125]
    v_pk_fma_f32 v[126:127], v[126:127], v[58:59], v[126:127]
    v_pk_fma_f32 v[120:121], v[120:121], v[52:53], v[120:121]
    v_pk_fma_f32 v[122:123], v[122:123], v[60:61], v[122:123]
    v_pk_fma_f32 v[120:121], v[36:37], v[124:125], v[120:121]
    v_pk_fma_f32 v[122:123], v[44:45], v[126:127], v[122:123]
    v_pk_fma_f32 v[124:125], v[124:125], v[52:53], v[124:125]
    v_pk_fma_f32 v[126:127], v[126:127], v[60:61], v[126:127]
    v_pk_fma_f32 v[120:121], v[120:121], v[54:55], v[120:121]
    v_pk_fma_f32 v[122:123], v[122:123], v[62:63], v[122:123]
    v_pk_fma_f32 v[120:121], v[38:39], v[124:125], v[120:121]
    v_pk_fma_f32 v[122:123], v[46:47], v[126:127], v[122:123]
    v_pk_fma_f32 v[124:125], v[124:125], v[54:55], v[124:125]
    v_pk_fma_f32 v[126:127], v[126:127], v[62:63], v[126:127]
    v_mfma_f32_32x32x16_bf16 v[32:47], v[64:67], a[12:15], 0
    v_rcp_f32 v128, v124
    v_rcp_f32 v129, v125
    v_rcp_f32 v130, v126
    v_mfma_f32_32x32x16_bf16 v[32:47], v[68:71], a[28:31], v[32:47]
    v_rcp_f32 v131, v127
    v_exp_f32 v48, v16
    v_exp_f32 v49, v17
    v_mfma_f32_32x32x16_bf16 v[32:47], v[72:75], a[44:47], v[32:47]
    v_exp_f32 v56, v24
    v_exp_f32 v57, v25
    v_exp_f32 v50, v18
    v_mfma_f32_32x32x16_bf16 v[32:47], v[76:79], a[60:63], v[32:47]
    v_exp_f32 v51, v19
    v_exp_f32 v58, v26
    v_exp_f32 v59, v27
    v_mfma_f32_32x32x16_bf16 v[32:47], v[80:83], a[76:79], v[32:47]
    v_exp_f32 v52, v20
    v_exp_f32 v53, v21
    v_exp_f32 v60, v28
    v_mfma_f32_32x32x16_bf16 v[32:47], v[84:87], v[100:103], v[32:47]
    v_exp_f32 v61, v29
    v_exp_f32 v54, v22
    v_exp_f32 v55, v23
    v_exp_f32 v62, v30
    v_exp_f32 v63, v31
    s_sub_u32 s26, s26, 1
    s_cbranch_scc1 G_last1
    s_waitcnt vmcnt(5) lgkmcnt(0)
    v_and_or_b32 v144, v142, s64, v155
    v_pk_fma_f32 v[164:165], v[124:125], v[126:127], v[164:165]
    ds_read_b128 v[64:67], v150 offset:0
    v_pk_fma_f32 v[108:109], v[120:121], v[128:129], v[108:109]
    ds_read_b128 v[68:71], v151 offset:0
    v_pk_fma_f32 v[110:111], v[122:123], v[130:131], v[110:111]
    ds_read_b128 v[72:75], v152 offset:0
    v_pk_add_f32 v[124:125], v[48:49], 1.0 op_sel_hi:[1,0]
    ds_read_b128 v[76:79], v153 offset:0
    v_pk_add_f32 v[126:127], v[56:57], 1.0 op_sel_hi:[1,0]
    ds_read_b128 v[80:83], v154 offset:0
    v_pk_fma_f32 v[120:121], v[16:17], v[50:51], v[16:17]
    ds_read_b128 v[84:87], v144 offset:0
    v_pk_fma_f32 v[122:123], v[24:25], v[58:59], v[24:25]
    v_pk_fma_f32 v[120:121], v[18:19], v[124:125], v[120:121]
    v_pk_fma_f32 v[122:123], v[26:27], v[126:127], v[122:123]
    v_pk_fma_f32 v[124:125], v[124:125], v[50:51], v[124:125]
    v_pk_fma_f32 v[126:127], v[126:127], v[58:59], v[126:127]
    v_pk_fma_f32 v[120:121], v[120:121], v[52:53], v[120:121]
    v_pk_fma_f32 v[122:123], v[122:123], v[60:61], v[122:123]
    v_pk_fma_f32 v[120:121], v[20:21], v[124:125], v[120:121]
    v_pk_fma_f32 v[122:123], v[28:29], v[126:127], v[122:123]
    v_pk_fma_f32 v[124:125], v[124:125], v[52:53], v[124:125]
    v_pk_fma_f32 v[126:127], v[126:127], v[60:61], v[126:127]
    v_pk_fma_f32 v[120:121], v[120:121], v[54:55], v[120:121]
    v_pk_fma_f32 v[122:123], v[122:123], v[62:63], v[122:123]
    v_pk_fma_f32 v[120:121], v[22:23], v[124:125], v[120:121]
    v_pk_fma_f32 v[122:123], v[30:31], v[126:127], v[122:123]
    v_pk_fma_f32 v[124:125], v[124:125], v[54:55], v[124:125]
    v_pk_fma_f32 v[126:127], v[126:127], v[62:63], v[126:127]
    s_waitcnt lgkmcnt(0)
    v_mfma_f32_32x32x16_bf16 v[16:31], v[64:67], a[0:3], 0
    v_rcp_f32 v128, v124
    v_rcp_f32 v129, v125
    v_rcp_f32 v130, v126
    v_mfma_f32_32x32x16_bf16 v[16:31], v[68:71], a[16:19], v[16:31]
    v_rcp_f32 v131, v127
    v_exp_f32 v48, v32
    v_exp_f32 v49, v33
    v_mfma_f32_32x32x16_bf16 v[16:31], v[72:75], a[32:35], v[16:31]
    v_exp_f32 v56, v40
    v_exp_f32 v57, v41
    v_exp_f32 v50, v34
    v_mfma_f32_32x32x16_bf16 v[16:31], v[76:79], a[48:51], v[16:31]
    v_exp_f32 v51, v35
    v_exp_f32 v58, v42
    v_exp_f32 v59, v43
    v_mfma_f32_32x32x16_bf16 v[16:31], v[80:83], a[64:67], v[16:31]
    v_exp_f32 v52, v36
    v_exp_f32 v53, v37
    v_exp_f32 v60, v44
    v_mfma_f32_32x32x16_bf16 v[16:31], v[84:87], v[88:91], v[16:31]
    v_exp_f32 v61, v45
    v_exp_f32 v54, v38
    v_exp_f32 v55, v39
    v_exp_f32 v62, v46
    v_exp_f32 v63, v47
    v_add_u32 v146, 64, v146
    v_add_u32 v147, 64, v147
    v_add_u32 v148, 64, v148
    v_add_u32 v149, 64, v149
    v_pk_fma_f32 v[164:165], v[124:125], v[126:127], v[164:165]
    v_pk_fma_f32 v[112:113], v[120:121], v[128:129], v[112:113]
    s_cmp_gt_u32 s26, 1
    v_pk_fma_f32 v[114:115], v[122:123], v[130:131], v[114:115]
    v_pk_add_f32 v[124:125], v[48:49], 1.0 op_sel_hi:[1,0]
    s_cselect_b32 s6, 10000, 0
    v_pk_add_f32 v[126:127], v[56:57], 1.0 op_sel_hi:[1,0]
    v_pk_fma_f32 v[120:121], v[32:33], v[50:51], v[32:33]
    s_cselect_b32 s10, 640000, 0
    v_pk_fma_f32 v[122:123], v[40:41], v[58:59], v[40:41]
    v_pk_fma_f32 v[120:121], v[34:35], v[124:125], v[120:121]
    s_add_u32 m0, s27, 4096
    v_pk_fma_f32 v[122:123], v[42:43], v[126:127], v[122:123]
    v_pk_fma_f32 v[124:125], v[124:125], v[50:51], v[124:125]
    buffer_load_dwordx4 v[140:141], s[8:11], 0 idxen offen lds
    v_pk_fma_f32 v[126:127], v[126:127], v[58:59], v[126:127]
    v_pk_fma_f32 v[120:121], v[120:121], v[52:53], v[120:121]
    s_add_u32 m0, s27, 0
    v_pk_fma_f32 v[122:123], v[122:123], v[60:61], v[122:123]
    v_pk_fma_f32 v[120:121], v[36:37], v[124:125], v[120:121]
    buffer_load_dwordx4 v[132:133], s[4:7], 0 idxen offen offset:0 lds
    v_pk_fma_f32 v[122:123], v[44:45], v[126:127], v[122:123]
    v_pk_fma_f32 v[124:125], v[124:125], v[52:53], v[124:125]
    buffer_load_dwordx4 v[134:135], s[4:7], 0 idxen offen offset:1024 lds
    v_pk_fma_f32 v[126:127], v[126:127], v[60:61], v[126:127]
    v_pk_fma_f32 v[120:121], v[120:121], v[54:55], v[120:121]
    buffer_load_dwordx4 v[136:137], s[4:7], 0 idxen offen offset:2048 lds
    v_pk_fma_f32 v[122:123], v[122:123], v[62:63], v[122:123]
    v_pk_fma_f32 v[120:121], v[38:39], v[124:125], v[120:121]
    buffer_load_dwordx4 v[138:139], s[4:7], 0 idxen offen offset:3072 lds
    v_pk_fma_f32 v[122:123], v[46:47], v[126:127], v[122:123]
    v_pk_fma_f32 v[124:125], v[124:125], v[54:55], v[124:125]
    v_pk_fma_f32 v[126:127], v[126:127], v[62:63], v[126:127]
    s_branch G_it0
G_last0:
    s_waitcnt lgkmcnt(0)
    v_mov_b32 v143, v142
G_last1:
    v_pk_fma_f32 v[164:165], v[124:125], v[126:127], v[164:165]
    v_pk_fma_f32 v[108:109], v[120:121], v[128:129], v[108:109]
    v_pk_fma_f32 v[110:111], v[122:123], v[130:131], v[110:111]
    v_pk_add_f32 v[124:125], v[48:49], 1.0 op_sel_hi:[1,0]
    v_pk_add_f32 v[126:127], v[56:57], 1.0 op_sel_hi:[1,0]
    v_pk_fma_f32 v[120:121], v[16:17], v[50:51], v[16:17]
    v_pk_fma_f32 v[122:123], v[24:25], v[58:59], v[24:25]
    v_pk_fma_f32 v[120:121], v[18:19], v[124:125], v[120:121]
    v_pk_fma_f32 v[122:123], v[26:27], v[126:127], v[122:123]
    v_pk_fma_f32 v[124:125], v[124:125], v[50:51], v[124:125]
    v_pk_fma_f32 v[126:127], v[126:127], v[58:59], v[126:127]
    v_pk_fma_f32 v[120:121], v[120:121], v[52:53], v[120:121]
    v_pk_fma_f32 v[122:123], v[122:123], v[60:61], v[122:123]
    v_pk_fma_f32 v[120:121], v[20:21], v[124:125], v[120:121]
    v_pk_fma_f32 v[122:123], v[28:29], v[126:127], v[122:123]
    v_pk_fma_f32 v[124:125], v[124:125], v[52:53], v[124:125]
    v_pk_fma_f32 v[126:127], v[126:127], v[60:61], v[126:127]
    v_pk_fma_f32 v[120:121], v[120:121], v[54:55], v[120:121]
    v_pk_fma_f32 v[122:123], v[122:123], v[62:63], v[122:123]
    v_pk_fma_f32 v[120:121], v[22:23], v[124:125], v[120:121]
    v_pk_fma_f32 v[122:123], v[30:31], v[126:127], v[122:123]
    v_pk_fma_f32 v[124:125], v[124:125], v[54:55], v[124:125]
    v_pk_fma_f32 v[126:127], v[126:127], v[62:63], v[126:127]
    v_rcp_f32 v128, v124
    v_rcp_f32 v129, v125
    v_rcp_f32 v130, v126
    v_rcp_f32 v131, v127
    v_exp_f32 v48, v32
    v_exp_f32 v49, v33
    v_exp_f32 v56, v40
    v_exp_f32 v57, v41
    v_exp_f32 v50, v34
    v_exp_f32 v51, v35
    v_exp_f32 v58, v42
    v_exp_f32 v59, v43
    v_exp_f32 v52, v36
    v_exp_f32 v53, v37
    v_exp_f32 v60, v44
    v_exp_f32 v61, v45
    v_exp_f32 v54, v38
    v_exp_f32 v55, v39
    v_exp_f32 v62, v46
    v_exp_f32 v63, v47
    v_pk_fma_f32 v[164:165], v[124:125], v[126:127], v[164:165]
    v_pk_fma_f32 v[112:113], v[120:121], v[128:129], v[112:113]
    v_pk_fma_f32 v[114:115], v[122:123], v[130:131], v[114:115]
    v_pk_add_f32 v[124:125], v[48:49], 1.0 op_sel_hi:[1,0]
    v_pk_add_f32 v[126:127], v[56:57], 1.0 op_sel_hi:[1,0]
    v_pk_fma_f32 v[120:121], v[32:33], v[50:51], v[32:33]
    v_pk_fma_f32 v[122:123], v[40:41], v[58:59], v[40:41]
    v_pk_fma_f32 v[120:121], v[34:35], v[124:125], v[120:121]
    v_pk_fma_f32 v[122:123], v[42:43], v[126:127], v[122:123]
    v_pk_fma_f32 v[124:125], v[124:125], v[50:51], v[124:125]
    v_pk_fma_f32 v[126:127], v[126:127], v[58:59], v[126:127]
    v_pk_fma_f32 v[120:121], v[120:121], v[52:53], v[120:121]
    v_pk_fma_f32 v[122:123], v[122:123], v[60:61], v[122:123]
    v_pk_fma_f32 v[120:121], v[36:37], v[124:125], v[120:121]
    v_pk_fma_f32 v[122:123], v[44:45], v[126:127], v[122:123]
    v_pk_fma_f32 v[124:125], v[124:125], v[52:53], v[124:125]
    v_pk_fma_f32 v[126:127], v[126:127], v[60:61], v[126:127]
    v_pk_fma_f32 v[120:121], v[120:121], v[54:55], v[120:121]
    v_pk_fma_f32 v[122:123], v[122:123], v[62:63], v[122:123]
    v_pk_fma_f32 v[120:121], v[38:39], v[124:125], v[120:121]
    v_pk_fma_f32 v[122:123], v[46:47], v[126:127], v[122:123]
    v_pk_fma_f32 v[124:125], v[124:125], v[54:55], v[124:125]
    v_pk_fma_f32 v[126:127], v[126:127], v[62:63], v[126:127]
    s_branch F_tail1
G_fl0:
    s_bitcmp1_b32 vcc_lo, 2
    s_cbranch_scc0 G_fl0_go
    s_cmp_gt_u32 s25, 2
    s_cselect_b32 s6, 10000, 0
    s_cselect_b32 s10, 640000, 0
    s_waitcnt lgkmcnt(0)
    s_add_u32 m0, s27, 4096
    s_nop 0
    buffer_load_dwordx4 v[140:141], s[8:11], 0 idxen offen lds
    s_add_u32 m0, s27, 0
    s_nop 0
    buffer_load_dwordx4 v[132:133], s[4:7], 0 idxen offen offset:0 lds
    buffer_load_dwordx4 v[134:135], s[4:7], 0 idxen offen offset:1024 lds
    buffer_load_dwordx4 v[136:137], s[4:7], 0 idxen offen offset:2048 lds
    buffer_load_dwordx4 v[138:139], s[4:7], 0 idxen offen offset:3072 lds
    s_branch G_flr0
G_fl0_go:
    s_and_b32 s30, vcc_lo, 0x33
    s_cbranch_scc0 G_fl0_u1
    s_and_b32 s30, vcc_lo, 0x3
    s_cbranch_scc0 G_fl0_0h1
    s_bitcmp1_b32 vcc_lo, 0
    s_cbranch_scc0 G_fl0_00p1
    v_readlane_b32 s30, v143, 0
    s_mov_b64 exec, s[66:67]
    s_bfe_u32 s30, s30, 0x60005
    s_mul_i32 s30, s30, 528
    v_add_u32 v157, s30, v156
    ds_write_b32 v157, v104 offset:0
    ds_write_b32 v157, v108 offset:128
    ds_write_b32 v157, v112 offset:256
    ds_write_b32 v157, v116 offset:384
    v_mul_f32 v104, 0, v104
    v_mul_f32 v108, 0, v108
    v_mul_f32 v112, 0, v112
    v_mul_f32 v116, 0, v116
    s_mov_b64 exec, -1
    s_and_b32 vcc_lo, vcc_lo, 0x330032
    s_cbranch_scc0 G_flr0
    s_branch G_fl0_go
G_fl0_00p1:
    v_readlane_b32 s30, v143, 1
    s_mov_b64 exec, s[66:67]
    s_bfe_u32 s30, s30, 0x60005
    s_mul_i32 s30, s30, 528
    v_add_u32 v157, s30, v156
    ds_write_b32 v157, v105 offset:0
    ds_write_b32 v157, v109 offset:128
    ds_write_b32 v157, v113 offset:256
    ds_write_b32 v157, v117 offset:384
    v_mul_f32 v105, 0, v105
    v_mul_f32 v109, 0, v109
    v_mul_f32 v113, 0, v113
    v_mul_f32 v117, 0, v117
    s_mov_b64 exec, -1
    s_and_b32 vcc_lo, vcc_lo, 0x330031
    s_cbranch_scc0 G_flr0
    s_branch G_fl0_go
G_fl0_0h1:
    s_bitcmp1_b32 vcc_lo, 4
    s_cbranch_scc0 G_fl0_01p1
    v_readlane_b32 s30, v143, 4
    s_mov_b64 exec, s[68:69]
    s_bfe_u32 s30, s30, 0x60005
    s_mul_i32 s30, s30, 528
    v_add_u32 v157, s30, v156
    ds_write_b32 v157, v104 offset:0
    ds_write_b32 v157, v108 offset:128
    ds_write_b32 v157, v112 offset:256
    ds_write_b32 v157, v116 offset:384
    v_mul_f32 v104, 0, v104
    v_mul_f32 v108, 0, v108
    v_mul_f32 v112, 0, v112
    v_mul_f32 v116, 0, v116
    s_mov_b64 exec, -1
    s_and_b32 vcc_lo, vcc_lo, 0x330023
    s_cbranch_scc0 G_flr0
    s_branch G_fl0_go
G_fl0_01p1:
    v_readlane_b32 s30, v143, 5
    s_mov_b64 exec, s[68:69]
    s_bfe_u32 s30, s30, 0x60005
    s_mul_i32 s30, s30, 528
    v_add_u32 v157, s30, v156
    ds_write_b32 v157, v105 offset:0
    ds_write_b32 v157, v109 offset:128
    ds_write_b32 v157, v113 offset:256
    ds_write_b32 v157, v117 offset:384
    v_mul_f32 v105, 0, v105
    v_mul_f32 v109, 0, v109
    v_mul_f32 v113, 0, v113
    v_mul_f32 v117, 0, v117
    s_mov_b64 exec, -1
    s_and_b32 vcc_lo, vcc_lo, 0x330013
    s_cbranch_scc0 G_flr0
    s_branch G_fl0_go
G_fl0_u1:
    s_and_b32 s30, vcc_lo, 0x330000
    s_cbranch_scc0 G_flr0
    s_and_b32 s30, vcc_lo, 0x30000
    s_cbranch_scc0 G_fl0_1h1
    s_bitcmp1_b32 vcc_lo, 16
    s_cbranch_scc0 G_fl0_10p1
    v_readlane_b32 s30, v143, 16
    s_mov_b64 exec, s[66:67]
    s_bfe_u32 s30, s30, 0x60005
    s_mul_i32 s30, s30, 528
    v_add_u32 v157, s30, v156
    ds_write_b32 v157, v106 offset:0
    ds_write_b32 v157, v110 offset:128
    ds_write_b32 v157, v114 offset:256
    ds_write_b32 v157, v118 offset:384
    v_mul_f32 v106, 0, v106
    v_mul_f32 v110, 0, v110
    v_mul_f32 v114, 0, v114
    v_mul_f32 v118, 0, v118
    s_mov_b64 exec, -1
    s_and_b32 vcc_lo, vcc_lo, 0x320033
    s_cbranch_scc0 G_flr0
    s_branch G_fl0_go
G_fl0_10p1:
    v_readlane_b32 s30, v143, 17
    s_mov_b64 exec, s[66:67]
    s_bfe_u32 s30, s30, 0x60005
    s_mul_i32 s30, s30, 528
    v_add_u32 v157, s30, v156
    ds_write_b32 v157, v107 offset:0
    ds_write_b32 v157, v111 offset:128
    ds_write_b32 v157, v115 offset:256
    ds_write_b32 v157, v119 offset:384
    v_mul_f32 v107, 0, v107
    v_mul_f32 v111, 0, v111
    v_mul_f32 v115, 0, v115
    v_mul_f32 v119, 0, v119
    s_mov_b64 exec, -1
    s_and_b32 vcc_lo, vcc_lo, 0x310033
    s_cbranch_scc0 G_flr0
    s_branch G_fl0_go
G_fl0_1h1:
    s_bitcmp1_b32 vcc_lo, 20
    s_cbranch_scc0 G_fl0_11p1
    v_readlane_b32 s30, v143, 20
    s_mov_b64 exec, s[68:69]
    s_bfe_u32 s30, s30, 0x60005
    s_mul_i32 s30, s30, 528
    v_add_u32 v157, s30, v156
    ds_write_b32 v157, v106 offset:0
    ds_write_b32 v157, v110 offset:128
    ds_write_b32 v157, v114 offset:256
    ds_write_b32 v157, v118 offset:384
    v_mul_f32 v106, 0, v106
    v_mul_f32 v110, 0, v110
    v_mul_f32 v114, 0, v114
    v_mul_f32 v118, 0, v118
    s_mov_b64 exec, -1
    s_and_b32 vcc_lo, vcc_lo, 0x230033
    s_cbranch_scc0 G_flr0
    s_branch G_fl0_go
G_fl0_11p1:
    v_readlane_b32 s30, v143, 21
    s_mov_b64 exec, s[68:69]
    s_bfe_u32 s30, s30, 0x60005
    s_mul_i32 s30, s30, 528
    v_add_u32 v157, s30, v156
    ds_write_b32 v157, v107 offset:0
    ds_write_b32 v157, v111 offset:128
    ds_write_b32 v157, v115 offset:256
    ds_write_b32 v157, v119 offset:384
    v_mul_f32 v107, 0, v107
    v_mul_f32 v111, 0, v111
    v_mul_f32 v115, 0, v115
    v_mul_f32 v119, 0, v119
    s_mov_b64 exec, -1
    s_and_b32 vcc_lo, vcc_lo, 0x130033
    s_cbranch_scc0 G_flr0
    s_branch G_fl0_go
G_fl1:
G_fl1_go:
    s_and_b32 s30, vcc_lo, 0x33
    s_cbranch_scc0 G_fl1_u1
    s_and_b32 s30, vcc_lo, 0x3
    s_cbranch_scc0 G_fl1_0h1
    s_bitcmp1_b32 vcc_lo, 0
    s_cbranch_scc0 G_fl1_00p1
    v_readlane_b32 s30, v142, 0
    s_mov_b64 exec, s[66:67]
    s_bfe_u32 s30, s30, 0x60005
    s_mul_i32 s30, s30, 528
    v_add_u32 v157, s30, v156
    ds_write_b32 v157, v104 offset:0
    ds_write_b32 v157, v108 offset:128
    ds_write_b32 v157, v112 offset:256
    ds_write_b32 v157, v116 offset:384
    v_mul_f32 v104, 0, v104
    v_mul_f32 v108, 0, v108
    v_mul_f32 v112, 0, v112
    v_mul_f32 v116, 0, v116
    s_mov_b64 exec, -1
    s_and_b32 vcc_lo, vcc_lo, 0x330032
    s_cbranch_scc0 G_flr1
    s_branch G_fl1_go
G_fl1_00p1:
    v_readlane_b32 s30, v142, 1
    s_mov_b64 exec, s[66:67]
    s_bfe_u32 s30, s30, 0x60005
    s_mul_i32 s30, s30, 528
    v_add_u32 v157, s30, v156
    ds_write_b32 v157, v105 offset:0
    ds_write_b32 v157, v109 offset:128
    ds_write_b32 v157, v113 offset:256
    ds_write_b32 v157, v117 offset:384
    v_mul_f32 v105, 0, v105
    v_mul_f32 v109, 0, v109
    v_mul_f32 v113, 0, v113
    v_mul_f32 v117, 0, v117
    s_mov_b64 exec, -1
    s_and_b32 vcc_lo, vcc_lo, 0x330031
    s_cbranch_scc0 G_flr1
    s_branch G_fl1_go
G_fl1_0h1:
    s_bitcmp1_b32 vcc_lo, 4
    s_cbranch_scc0 G_fl1_01p1
    v_readlane_b32 s30, v142, 4
    s_mov_b64 exec, s[68:69]
    s_bfe_u32 s30, s30, 0x60005
    s_mul_i32 s30, s30, 528
    v_add_u32 v157, s30, v156
    ds_write_b32 v157, v104 offset:0
    ds_write_b32 v157, v108 offset:128
    ds_write_b32 v157, v112 offset:256
    ds_write_b32 v157, v116 offset:384
    v_mul_f32 v104, 0, v104
    v_mul_f32 v108, 0, v108
    v_mul_f32 v112, 0, v112
    v_mul_f32 v116, 0, v116
    s_mov_b64 exec, -1
    s_and_b32 vcc_lo, vcc_lo, 0x330023
    s_cbranch_scc0 G_flr1
    s_branch G_fl1_go
G_fl1_01p1:
    v_readlane_b32 s30, v142, 5
    s_mov_b64 exec, s[68:69]
    s_bfe_u32 s30, s30, 0x60005
    s_mul_i32 s30, s30, 528
    v_add_u32 v157, s30, v156
    ds_write_b32 v157, v105 offset:0
    ds_write_b32 v157, v109 offset:128
    ds_write_b32 v157, v113 offset:256
    ds_write_b32 v157, v117 offset:384
    v_mul_f32 v105, 0, v105
    v_mul_f32 v109, 0, v109
    v_mul_f32 v113, 0, v113
    v_mul_f32 v117, 0, v117
    s_mov_b64 exec, -1
    s_and_b32 vcc_lo, vcc_lo, 0x330013
    s_cbranch_scc0 G_flr1
    s_branch G_fl1_go
G_fl1_u1:
    s_and_b32 s30, vcc_lo, 0x330000
    s_cbranch_scc0 G_flr1
    s_and_b32 s30, vcc_lo, 0x30000
    s_cbranch_scc0 G_fl1_1h1
    s_bitcmp1_b32 vcc_lo, 16
    s_cbranch_scc0 G_fl1_10p1
    v_readlane_b32 s30, v142, 16
    s_mov_b64 exec, s[66:67]
    s_bfe_u32 s30, s30, 0x60005
    s_mul_i32 s30, s30, 528
    v_add_u32 v157, s30, v156
    ds_write_b32 v157, v106 offset:0
    ds_write_b32 v157, v110 offset:128
    ds_write_b32 v157, v114 offset:256
    ds_write_b32 v157, v118 offset:384
    v_mul_f32 v106, 0, v106
    v_mul_f32 v110, 0, v110
    v_mul_f32 v114, 0, v114
    v_mul_f32 v118, 0, v118
    s_mov_b64 exec, -1
    s_and_b32 vcc_lo, vcc_lo, 0x320033
    s_cbranch_scc0 G_flr1
    s_branch G_fl1_go
G_fl1_10p1:
    v_readlane_b32 s30, v142, 17
    s_mov_b64 exec, s[66:67]
    s_bfe_u32 s30, s30, 0x60005
    s_mul_i32 s30, s30, 528
    v_add_u32 v157, s30, v156
    ds_write_b32 v157, v107 offset:0
    ds_write_b32 v157, v111 offset:128
    ds_write_b32 v157, v115 offset:256
    ds_write_b32 v157, v119 offset:384
    v_mul_f32 v107, 0, v107
    v_mul_f32 v111, 0, v111
    v_mul_f32 v115, 0, v115
    v_mul_f32 v119, 0, v119
    s_mov_b64 exec, -1
    s_and_b32 vcc_lo, vcc_lo, 0x310033
    s_cbranch_scc0 G_flr1
    s_branch G_fl1_go
G_fl1_1h1:
    s_bitcmp1_b32 vcc_lo, 20
    s_cbranch_scc0 G_fl1_11p1
    v_readlane_b32 s30, v142, 20
    s_mov_b64 exec, s[68:69]
    s_bfe_u32 s30, s30, 0x60005
    s_mul_i32 s30, s30, 528
    v_add_u32 v157, s30, v156
    ds_write_b32 v157, v106 offset:0
    ds_write_b32 v157, v110 offset:128
    ds_write_b32 v157, v114 offset:256
    ds_write_b32 v157, v118 offset:384
    v_mul_f32 v106, 0, v106
    v_mul_f32 v110, 0, v110
    v_mul_f32 v114, 0, v114
    v_mul_f32 v118, 0, v118
    s_mov_b64 exec, -1
    s_and_b32 vcc_lo, vcc_lo, 0x230033
    s_cbranch_scc0 G_flr1
    s_branch G_fl1_go
G_fl1_11p1:
    v_readlane_b32 s30, v142, 21
    s_mov_b64 exec, s[68:69]
    s_bfe_u32 s30, s30, 0x60005
    s_mul_i32 s30, s30, 528
    v_add_u32 v157, s30, v156
    ds_write_b32 v157, v107 offset:0
    ds_write_b32 v157, v111 offset:128
    ds_write_b32 v157, v115 offset:256
    ds_write_b32 v157, v119 offset:384
    v_mul_f32 v107, 0, v107
    v_mul_f32 v111, 0, v111
    v_mul_f32 v115, 0, v115
    v_mul_f32 v119, 0, v119
    s_mov_b64 exec, -1
    s_and_b32 vcc_lo, vcc_lo, 0x130033
    s_cbranch_scc0 G_flr1
    s_branch G_fl1_go
K_SLOW:
    s_setprio 0
    s_waitcnt vmcnt(0) lgkmcnt(0)
    s_barrier
    v_lshrrev_b32 v157, 5, v1
    v_and_b32 v158, 31, v1
    v_lshlrev_b32 v156, 2, v158
    v_add_u32 v156, 27904, v156
    v_bfe_u32 v159, v1, 1, 3
    v_xor_b32 v159, v159, v157
    v_lshlrev_b32 v154, 7, v158
    v_add_u32 v154, s27, v154
    v_xor_b32 v150, 0, v159
    v_lshl_add_u32 v150, v150, 4, v154
    v_xor_b32 v151, 2, v159
    v_lshl_add_u32 v151, v151, 4, v154
    v_xor_b32 v152, 4, v159
    v_lshl_add_u32 v152, v152, 4, v154
    v_xor_b32 v153, 6, v159
    v_lshl_add_u32 v153, v153, 4, v154
    v_bfe_u32 v159, v1, 3, 1
    v_xor_b32 v159, v159, v157
    v_lshlrev_b32 v159, 4, v159
    v_lshl_add_u32 v154, v158, 5, v159
    s_add_u32 s30, s27, 4096
    v_add_u32 v154, s30, v154
    v_lshrrev_b32 v157, 4, v1
    v_and_b32 v159, 7, v1
    v_xor_b32 v159, v159, v157
    v_lshlrev_b32 v159, 4, v159
    v_xor_b32 v139, 64, v159
    v_or_b32 v137, 0x400, v159
    v_or_b32 v135, 0x800, v139
    v_or_b32 v133, 0xc00, v159
    v_xor_b32 v159, v1, v157
    v_and_b32 v159, 1, v159
    v_lshlrev_b32 v141, 4, v159
    s_load_dwordx2 s[96:97], s[0:1], 32
    s_mov_b32 s98, 36864
    s_mov_b32 s99, 0x20000
    v_lshlrev_b32 v13, 4, v1
    s_lshl_b32 s3, s24, 10
    s_waitcnt lgkmcnt(0)
    s_add_u32 m0, s3, 79744
    s_nop 0
    buffer_load_dwordx4 v13, s[96:99], s3 offen lds
    s_add_u32 s3, s3, 0x2000
    s_add_u32 m0, s3, 79744
    s_nop 0
    buffer_load_dwordx4 v13, s[96:99], s3 offen lds
    s_add_u32 s3, s3, 0x2000
    s_add_u32 m0, s3, 79744
    s_nop 0
    buffer_load_dwordx4 v13, s[96:99], s3 offen lds
    s_add_u32 s3, s3, 0x2000
    s_add_u32 m0, s3, 79744
    s_nop 0
    buffer_load_dwordx4 v13, s[96:99], s3 offen lds
    s_add_u32 s3, s3, 0x2000
    s_add_u32 m0, s3, 79744
    s_nop 0
    buffer_load_dwordx4 v13, s[96:99], s3 offen lds
    s_add_u32 s3, s3, 0x2000
    v_bfe_u32 v4, v1, 2, 2
    v_lshrrev_b32 v5, 1, v155
    v_add_u32 v4, v4, v5
    v_lshlrev_b32 v4, 8, v4
    v_bfe_u32 v5, v1, 4, 1
    v_lshl_add_u32 v4, v5, 5, v4
    v_and_b32 v5, 3, v1
    v_lshl_add_u32 v4, v5, 3, v4
    v_add_u32 v4, 79744, v4
    s_mov_b32 s3, 3216550459
    s_waitcnt vmcnt(0)
    s_barrier
    ds_read_b64_tr_b16 v[16:17], v4 offset:0
    ds_read_b64_tr_b16 v[18:19], v4 offset:1024
    s_waitcnt lgkmcnt(0)
    v_lshlrev_b32 v20, 16, v16
    v_and_b32 v21, 0xffff0000, v16
    v_mul_f32 v20, s3, v20
    v_mul_f32 v21, s3, v21
    v_cvt_pk_bf16_f32 v20, v20, v21
    v_accvgpr_write_b32 a0, v20
    v_lshlrev_b32 v20, 16, v17
    v_and_b32 v21, 0xffff0000, v17
    v_mul_f32 v20, s3, v20
    v_mul_f32 v21, s3, v21
    v_cvt_pk_bf16_f32 v20, v20, v21
    v_accvgpr_write_b32 a1, v20
    v_lshlrev_b32 v20, 16, v18
    v_and_b32 v21, 0xffff0000, v18
    v_mul_f32 v20, s3, v20
    v_mul_f32 v21, s3, v21
    v_cvt_pk_bf16_f32 v20, v20, v21
    v_accvgpr_write_b32 a2, v20
    v_lshlrev_b32 v20, 16, v19
    v_and_b32 v21, 0xffff0000, v19
    v_mul_f32 v20, s3, v20
    v_mul_f32 v21, s3, v21
    v_cvt_pk_bf16_f32 v20, v20, v21
    v_accvgpr_write_b32 a3, v20
    ds_read_b64_tr_b16 v[16:17], v4 offset:64
    ds_read_b64_tr_b16 v[18:19], v4 offset:1088
    s_waitcnt lgkmcnt(0)
    v_lshlrev_b32 v20, 16, v16
    v_and_b32 v21, 0xffff0000, v16
    v_mul_f32 v20, s3, v20
    v_mul_f32 v21, s3, v21
    v_cvt_pk_bf16_f32 v20, v20, v21
    v_accvgpr_write_b32 a4, v20
    v_lshlrev_b32 v20, 16, v17
    v_and_b32 v21, 0xffff0000, v17
    v_mul_f32 v20, s3, v20
    v_mul_f32 v21, s3, v21
    v_cvt_pk_bf16_f32 v20, v20, v21
    v_accvgpr_write_b32 a5, v20
    v_lshlrev_b32 v20, 16, v18
    v_and_b32 v21, 0xffff0000, v18
    v_mul_f32 v20, s3, v20
    v_mul_f32 v21, s3, v21
    v_cvt_pk_bf16_f32 v20, v20, v21
    v_accvgpr_write_b32 a6, v20
    v_lshlrev_b32 v20, 16, v19
    v_and_b32 v21, 0xffff0000, v19
    v_mul_f32 v20, s3, v20
    v_mul_f32 v21, s3, v21
    v_cvt_pk_bf16_f32 v20, v20, v21
    v_accvgpr_write_b32 a7, v20
    ds_read_b64_tr_b16 v[16:17], v4 offset:128
    ds_read_b64_tr_b16 v[18:19], v4 offset:1152
    s_waitcnt lgkmcnt(0)
    v_lshlrev_b32 v20, 16, v16
    v_and_b32 v21, 0xffff0000, v16
    v_mul_f32 v20, s3, v20
    v_mul_f32 v21, s3, v21
    v_cvt_pk_bf16_f32 v20, v20, v21
    v_accvgpr_write_b32 a8, v20
    v_lshlrev_b32 v20, 16, v17
    v_and_b32 v21, 0xffff0000, v17
    v_mul_f32 v20, s3, v20
    v_mul_f32 v21, s3, v21
    v_cvt_pk_bf16_f32 v20, v20, v21
    v_accvgpr_write_b32 a9, v20
    v_lshlrev_b32 v20, 16, v18
    v_and_b32 v21, 0xffff0000, v18
    v_mul_f32 v20, s3, v20
    v_mul_f32 v21, s3, v21
    v_cvt_pk_bf16_f32 v20, v20, v21
    v_accvgpr_write_b32 a10, v20
    v_lshlrev_b32 v20, 16, v19
    v_and_b32 v21, 0xffff0000, v19
    v_mul_f32 v20, s3, v20
    v_mul_f32 v21, s3, v21
    v_cvt_pk_bf16_f32 v20, v20, v21
    v_accvgpr_write_b32 a11, v20
    ds_read_b64_tr_b16 v[16:17], v4 offset:192
    ds_read_b64_tr_b16 v[18:19], v4 offset:1216
    s_waitcnt lgkmcnt(0)
    v_lshlrev_b32 v20, 16, v16
    v_and_b32 v21, 0xffff0000, v16
    v_mul_f32 v20, s3, v20
    v_mul_f32 v21, s3, v21
    v_cvt_pk_bf16_f32 v20, v20, v21
    v_accvgpr_write_b32 a12, v20
    v_lshlrev_b32 v20, 16, v17
    v_and_b32 v21, 0xffff0000, v17
    v_mul_f32 v20, s3, v20
    v_mul_f32 v21, s3, v21
    v_cvt_pk_bf16_f32 v20, v20, v21
    v_accvgpr_write_b32 a13, v20
    v_lshlrev_b32 v20, 16, v18
    v_and_b32 v21, 0xffff0000, v18
    v_mul_f32 v20, s3, v20
    v_mul_f32 v21, s3, v21
    v_cvt_pk_bf16_f32 v20, v20, v21
    v_accvgpr_write_b32 a14, v20
    v_lshlrev_b32 v20, 16, v19
    v_and_b32 v21, 0xffff0000, v19
    v_mul_f32 v20, s3, v20
    v_mul_f32 v21, s3, v21
    v_cvt_pk_bf16_f32 v20, v20, v21
    v_accvgpr_write_b32 a15, v20
    ds_read_b64_tr_b16 v[16:17], v4 offset:4096
    ds_read_b64_tr_b16 v[18:19], v4 offset:5120
    s_waitcnt lgkmcnt(0)
    v_lshlrev_b32 v20, 16, v16
    v_and_b32 v21, 0xffff0000, v16
    v_mul_f32 v20, s3, v20
    v_mul_f32 v21, s3, v21
    v_cvt_pk_bf16_f32 v20, v20, v21
    v_accvgpr_write_b32 a16, v20
    v_lshlrev_b32 v20, 16, v17
    v_and_b32 v21, 0xffff0000, v17
    v_mul_f32 v20, s3, v20
    v_mul_f32 v21, s3, v21
    v_cvt_pk_bf16_f32 v20, v20, v21
    v_accvgpr_write_b32 a17, v20
    v_lshlrev_b32 v20, 16, v18
    v_and_b32 v21, 0xffff0000, v18
    v_mul_f32 v20, s3, v20
    v_mul_f32 v21, s3, v21
    v_cvt_pk_bf16_f32 v20, v20, v21
    v_accvgpr_write_b32 a18, v20
    v_lshlrev_b32 v20, 16, v19
    v_and_b32 v21, 0xffff0000, v19
    v_mul_f32 v20, s3, v20
    v_mul_f32 v21, s3, v21
    v_cvt_pk_bf16_f32 v20, v20, v21
    v_accvgpr_write_b32 a19, v20
    ds_read_b64_tr_b16 v[16:17], v4 offset:4160
    ds_read_b64_tr_b16 v[18:19], v4 offset:5184
    s_waitcnt lgkmcnt(0)
    v_lshlrev_b32 v20, 16, v16
    v_and_b32 v21, 0xffff0000, v16
    v_mul_f32 v20, s3, v20
    v_mul_f32 v21, s3, v21
    v_cvt_pk_bf16_f32 v20, v20, v21
    v_accvgpr_write_b32 a20, v20
    v_lshlrev_b32 v20, 16, v17
    v_and_b32 v21, 0xffff0000, v17
    v_mul_f32 v20, s3, v20
    v_mul_f32 v21, s3, v21
    v_cvt_pk_bf16_f32 v20, v20, v21
    v_accvgpr_write_b32 a21, v20
    v_lshlrev_b32 v20, 16, v18
    v_and_b32 v21, 0xffff0000, v18
    v_mul_f32 v20, s3, v20
    v_mul_f32 v21, s3, v21
    v_cvt_pk_bf16_f32 v20, v20, v21
    v_accvgpr_write_b32 a22, v20
    v_lshlrev_b32 v20, 16, v19
    v_and_b32 v21, 0xffff0000, v19
    v_mul_f32 v20, s3, v20
    v_mul_f32 v21, s3, v21
    v_cvt_pk_bf16_f32 v20, v20, v21
    v_accvgpr_write_b32 a23, v20
    ds_read_b64_tr_b16 v[16:17], v4 offset:4224
    ds_read_b64_tr_b16 v[18:19], v4 offset:5248
    s_waitcnt lgkmcnt(0)
    v_lshlrev_b32 v20, 16, v16
    v_and_b32 v21, 0xffff0000, v16
    v_mul_f32 v20, s3, v20
    v_mul_f32 v21, s3, v21
    v_cvt_pk_bf16_f32 v20, v20, v21
    v_accvgpr_write_b32 a24, v20
    v_lshlrev_b32 v20, 16, v17
    v_and_b32 v21, 0xffff0000, v17
    v_mul_f32 v20, s3, v20
    v_mul_f32 v21, s3, v21
    v_cvt_pk_bf16_f32 v20, v20, v21
    v_accvgpr_write_b32 a25, v20
    v_lshlrev_b32 v20, 16, v18
    v_and_b32 v21, 0xffff0000, v18
    v_mul_f32 v20, s3, v20
    v_mul_f32 v21, s3, v21
    v_cvt_pk_bf16_f32 v20, v20, v21
    v_accvgpr_write_b32 a26, v20
    v_lshlrev_b32 v20, 16, v19
    v_and_b32 v21, 0xffff0000, v19
    v_mul_f32 v20, s3, v20
    v_mul_f32 v21, s3, v21
    v_cvt_pk_bf16_f32 v20, v20, v21
    v_accvgpr_write_b32 a27, v20
    ds_read_b64_tr_b16 v[16:17], v4 offset:4288
    ds_read_b64_tr_b16 v[18:19], v4 offset:5312
    s_waitcnt lgkmcnt(0)
    v_lshlrev_b32 v20, 16, v16
    v_and_b32 v21, 0xffff0000, v16
    v_mul_f32 v20, s3, v20
    v_mul_f32 v21, s3, v21
    v_cvt_pk_bf16_f32 v20, v20, v21
    v_accvgpr_write_b32 a28, v20
    v_lshlrev_b32 v20, 16, v17
    v_and_b32 v21, 0xffff0000, v17
    v_mul_f32 v20, s3, v20
    v_mul_f32 v21, s3, v21
    v_cvt_pk_bf16_f32 v20, v20, v21
    v_accvgpr_write_b32 a29, v20
    v_lshlrev_b32 v20, 16, v18
    v_and_b32 v21, 0xffff0000, v18
    v_mul_f32 v20, s3, v20
    v_mul_f32 v21, s3, v21
    v_cvt_pk_bf16_f32 v20, v20, v21
    v_accvgpr_write_b32 a30, v20
    v_lshlrev_b32 v20, 16, v19
    v_and_b32 v21, 0xffff0000, v19
    v_mul_f32 v20, s3, v20
    v_mul_f32 v21, s3, v21
    v_cvt_pk_bf16_f32 v20, v20, v21
    v_accvgpr_write_b32 a31, v20
    ds_read_b64_tr_b16 v[16:17], v4 offset:8192
    ds_read_b64_tr_b16 v[18:19], v4 offset:9216
    s_waitcnt lgkmcnt(0)
    v_lshlrev_b32 v20, 16, v16
    v_and_b32 v21, 0xffff0000, v16
    v_mul_f32 v20, s3, v20
    v_mul_f32 v21, s3, v21
    v_cvt_pk_bf16_f32 v20, v20, v21
    v_accvgpr_write_b32 a32, v20
    v_lshlrev_b32 v20, 16, v17
    v_and_b32 v21, 0xffff0000, v17
    v_mul_f32 v20, s3, v20
    v_mul_f32 v21, s3, v21
    v_cvt_pk_bf16_f32 v20, v20, v21
    v_accvgpr_write_b32 a33, v20
    v_lshlrev_b32 v20, 16, v18
    v_and_b32 v21, 0xffff0000, v18
    v_mul_f32 v20, s3, v20
    v_mul_f32 v21, s3, v21
    v_cvt_pk_bf16_f32 v20, v20, v21
    v_accvgpr_write_b32 a34, v20
    v_lshlrev_b32 v20, 16, v19
    v_and_b32 v21, 0xffff0000, v19
    v_mul_f32 v20, s3, v20
    v_mul_f32 v21, s3, v21
    v_cvt_pk_bf16_f32 v20, v20, v21
    v_accvgpr_write_b32 a35, v20
    ds_read_b64_tr_b16 v[16:17], v4 offset:8256
    ds_read_b64_tr_b16 v[18:19], v4 offset:9280
    s_waitcnt lgkmcnt(0)
    v_lshlrev_b32 v20, 16, v16
    v_and_b32 v21, 0xffff0000, v16
    v_mul_f32 v20, s3, v20
    v_mul_f32 v21, s3, v21
    v_cvt_pk_bf16_f32 v20, v20, v21
    v_accvgpr_write_b32 a36, v20
    v_lshlrev_b32 v20, 16, v17
    v_and_b32 v21, 0xffff0000, v17
    v_mul_f32 v20, s3, v20
    v_mul_f32 v21, s3, v21
    v_cvt_pk_bf16_f32 v20, v20, v21
    v_accvgpr_write_b32 a37, v20
    v_lshlrev_b32 v20, 16, v18
    v_and_b32 v21, 0xffff0000, v18
    v_mul_f32 v20, s3, v20
    v_mul_f32 v21, s3, v21
    v_cvt_pk_bf16_f32 v20, v20, v21
    v_accvgpr_write_b32 a38, v20
    v_lshlrev_b32 v20, 16, v19
    v_and_b32 v21, 0xffff0000, v19
    v_mul_f32 v20, s3, v20
    v_mul_f32 v21, s3, v21
    v_cvt_pk_bf16_f32 v20, v20, v21
    v_accvgpr_write_b32 a39, v20
    ds_read_b64_tr_b16 v[16:17], v4 offset:8320
    ds_read_b64_tr_b16 v[18:19], v4 offset:9344
    s_waitcnt lgkmcnt(0)
    v_lshlrev_b32 v20, 16, v16
    v_and_b32 v21, 0xffff0000, v16
    v_mul_f32 v20, s3, v20
    v_mul_f32 v21, s3, v21
    v_cvt_pk_bf16_f32 v20, v20, v21
    v_accvgpr_write_b32 a40, v20
    v_lshlrev_b32 v20, 16, v17
    v_and_b32 v21, 0xffff0000, v17
    v_mul_f32 v20, s3, v20
    v_mul_f32 v21, s3, v21
    v_cvt_pk_bf16_f32 v20, v20, v21
    v_accvgpr_write_b32 a41, v20
    v_lshlrev_b32 v20, 16, v18
    v_and_b32 v21, 0xffff0000, v18
    v_mul_f32 v20, s3, v20
    v_mul_f32 v21, s3, v21
    v_cvt_pk_bf16_f32 v20, v20, v21
    v_accvgpr_write_b32 a42, v20
    v_lshlrev_b32 v20, 16, v19
    v_and_b32 v21, 0xffff0000, v19
    v_mul_f32 v20, s3, v20
    v_mul_f32 v21, s3, v21
    v_cvt_pk_bf16_f32 v20, v20, v21
    v_accvgpr_write_b32 a43, v20
    ds_read_b64_tr_b16 v[16:17], v4 offset:8384
    ds_read_b64_tr_b16 v[18:19], v4 offset:9408
    s_waitcnt lgkmcnt(0)
    v_lshlrev_b32 v20, 16, v16
    v_and_b32 v21, 0xffff0000, v16
    v_mul_f32 v20, s3, v20
    v_mul_f32 v21, s3, v21
    v_cvt_pk_bf16_f32 v20, v20, v21
    v_accvgpr_write_b32 a44, v20
    v_lshlrev_b32 v20, 16, v17
    v_and_b32 v21, 0xffff0000, v17
    v_mul_f32 v20, s3, v20
    v_mul_f32 v21, s3, v21
    v_cvt_pk_bf16_f32 v20, v20, v21
    v_accvgpr_write_b32 a45, v20
    v_lshlrev_b32 v20, 16, v18
    v_and_b32 v21, 0xffff0000, v18
    v_mul_f32 v20, s3, v20
    v_mul_f32 v21, s3, v21
    v_cvt_pk_bf16_f32 v20, v20, v21
    v_accvgpr_write_b32 a46, v20
    v_lshlrev_b32 v20, 16, v19
    v_and_b32 v21, 0xffff0000, v19
    v_mul_f32 v20, s3, v20
    v_mul_f32 v21, s3, v21
    v_cvt_pk_bf16_f32 v20, v20, v21
    v_accvgpr_write_b32 a47, v20
    ds_read_b64_tr_b16 v[16:17], v4 offset:12288
    ds_read_b64_tr_b16 v[18:19], v4 offset:13312
    s_waitcnt lgkmcnt(0)
    v_lshlrev_b32 v20, 16, v16
    v_and_b32 v21, 0xffff0000, v16
    v_mul_f32 v20, s3, v20
    v_mul_f32 v21, s3, v21
    v_cvt_pk_bf16_f32 v20, v20, v21
    v_accvgpr_write_b32 a48, v20
    v_lshlrev_b32 v20, 16, v17
    v_and_b32 v21, 0xffff0000, v17
    v_mul_f32 v20, s3, v20
    v_mul_f32 v21, s3, v21
    v_cvt_pk_bf16_f32 v20, v20, v21
    v_accvgpr_write_b32 a49, v20
    v_lshlrev_b32 v20, 16, v18
    v_and_b32 v21, 0xffff0000, v18
    v_mul_f32 v20, s3, v20
    v_mul_f32 v21, s3, v21
    v_cvt_pk_bf16_f32 v20, v20, v21
    v_accvgpr_write_b32 a50, v20
    v_lshlrev_b32 v20, 16, v19
    v_and_b32 v21, 0xffff0000, v19
    v_mul_f32 v20, s3, v20
    v_mul_f32 v21, s3, v21
    v_cvt_pk_bf16_f32 v20, v20, v21
    v_accvgpr_write_b32 a51, v20
    ds_read_b64_tr_b16 v[16:17], v4 offset:12352
    ds_read_b64_tr_b16 v[18:19], v4 offset:13376
    s_waitcnt lgkmcnt(0)
    v_lshlrev_b32 v20, 16, v16
    v_and_b32 v21, 0xffff0000, v16
    v_mul_f32 v20, s3, v20
    v_mul_f32 v21, s3, v21
    v_cvt_pk_bf16_f32 v20, v20, v21
    v_accvgpr_write_b32 a52, v20
    v_lshlrev_b32 v20, 16, v17
    v_and_b32 v21, 0xffff0000, v17
    v_mul_f32 v20, s3, v20
    v_mul_f32 v21, s3, v21
    v_cvt_pk_bf16_f32 v20, v20, v21
    v_accvgpr_write_b32 a53, v20
    v_lshlrev_b32 v20, 16, v18
    v_and_b32 v21, 0xffff0000, v18
    v_mul_f32 v20, s3, v20
    v_mul_f32 v21, s3, v21
    v_cvt_pk_bf16_f32 v20, v20, v21
    v_accvgpr_write_b32 a54, v20
    v_lshlrev_b32 v20, 16, v19
    v_and_b32 v21, 0xffff0000, v19
    v_mul_f32 v20, s3, v20
    v_mul_f32 v21, s3, v21
    v_cvt_pk_bf16_f32 v20, v20, v21
    v_accvgpr_write_b32 a55, v20
    ds_read_b64_tr_b16 v[16:17], v4 offset:12416
    ds_read_b64_tr_b16 v[18:19], v4 offset:13440
    s_waitcnt lgkmcnt(0)
    v_lshlrev_b32 v20, 16, v16
    v_and_b32 v21, 0xffff0000, v16
    v_mul_f32 v20, s3, v20
    v_mul_f32 v21, s3, v21
    v_cvt_pk_bf16_f32 v20, v20, v21
    v_accvgpr_write_b32 a56, v20
    v_lshlrev_b32 v20, 16, v17
    v_and_b32 v21, 0xffff0000, v17
    v_mul_f32 v20, s3, v20
    v_mul_f32 v21, s3, v21
    v_cvt_pk_bf16_f32 v20, v20, v21
    v_accvgpr_write_b32 a57, v20
    v_lshlrev_b32 v20, 16, v18
    v_and_b32 v21, 0xffff0000, v18
    v_mul_f32 v20, s3, v20
    v_mul_f32 v21, s3, v21
    v_cvt_pk_bf16_f32 v20, v20, v21
    v_accvgpr_write_b32 a58, v20
    v_lshlrev_b32 v20, 16, v19
    v_and_b32 v21, 0xffff0000, v19
    v_mul_f32 v20, s3, v20
    v_mul_f32 v21, s3, v21
    v_cvt_pk_bf16_f32 v20, v20, v21
    v_accvgpr_write_b32 a59, v20
    ds_read_b64_tr_b16 v[16:17], v4 offset:12480
    ds_read_b64_tr_b16 v[18:19], v4 offset:13504
    s_waitcnt lgkmcnt(0)
    v_lshlrev_b32 v20, 16, v16
    v_and_b32 v21, 0xffff0000, v16
    v_mul_f32 v20, s3, v20
    v_mul_f32 v21, s3, v21
    v_cvt_pk_bf16_f32 v20, v20, v21
    v_accvgpr_write_b32 a60, v20
    v_lshlrev_b32 v20, 16, v17
    v_and_b32 v21, 0xffff0000, v17
    v_mul_f32 v20, s3, v20
    v_mul_f32 v21, s3, v21
    v_cvt_pk_bf16_f32 v20, v20, v21
    v_accvgpr_write_b32 a61, v20
    v_lshlrev_b32 v20, 16, v18
    v_and_b32 v21, 0xffff0000, v18
    v_mul_f32 v20, s3, v20
    v_mul_f32 v21, s3, v21
    v_cvt_pk_bf16_f32 v20, v20, v21
    v_accvgpr_write_b32 a62, v20
    v_lshlrev_b32 v20, 16, v19
    v_and_b32 v21, 0xffff0000, v19
    v_mul_f32 v20, s3, v20
    v_mul_f32 v21, s3, v21
    v_cvt_pk_bf16_f32 v20, v20, v21
    v_accvgpr_write_b32 a63, v20
    ds_read_b64_tr_b16 v[16:17], v4 offset:32768
    ds_read_b64_tr_b16 v[18:19], v4 offset:33792
    s_waitcnt lgkmcnt(0)
    v_lshlrev_b32 v20, 16, v16
    v_and_b32 v21, 0xffff0000, v16
    v_mul_f32 v20, s3, v20
    v_mul_f32 v21, s3, v21
    v_cvt_pk_bf16_f32 v20, v20, v21
    v_accvgpr_write_b32 a64, v20
    v_lshlrev_b32 v20, 16, v17
    v_and_b32 v21, 0xffff0000, v17
    v_mul_f32 v20, s3, v20
    v_mul_f32 v21, s3, v21
    v_cvt_pk_bf16_f32 v20, v20, v21
    v_accvgpr_write_b32 a65, v20
    v_lshlrev_b32 v20, 16, v18
    v_and_b32 v21, 0xffff0000, v18
    v_mul_f32 v20, s3, v20
    v_mul_f32 v21, s3, v21
    v_cvt_pk_bf16_f32 v20, v20, v21
    v_accvgpr_write_b32 a66, v20
    v_lshlrev_b32 v20, 16, v19
    v_and_b32 v21, 0xffff0000, v19
    v_mul_f32 v20, s3, v20
    v_mul_f32 v21, s3, v21
    v_cvt_pk_bf16_f32 v20, v20, v21
    v_accvgpr_write_b32 a67, v20
    ds_read_b64_tr_b16 v[16:17], v4 offset:32832
    ds_read_b64_tr_b16 v[18:19], v4 offset:33856
    s_waitcnt lgkmcnt(0)
    v_lshlrev_b32 v20, 16, v16
    v_and_b32 v21, 0xffff0000, v16
    v_mul_f32 v20, s3, v20
    v_mul_f32 v21, s3, v21
    v_cvt_pk_bf16_f32 v20, v20, v21
    v_accvgpr_write_b32 a68, v20
    v_lshlrev_b32 v20, 16, v17
    v_and_b32 v21, 0xffff0000, v17
    v_mul_f32 v20, s3, v20
    v_mul_f32 v21, s3, v21
    v_cvt_pk_bf16_f32 v20, v20, v21
    v_accvgpr_write_b32 a69, v20
    v_lshlrev_b32 v20, 16, v18
    v_and_b32 v21, 0xffff0000, v18
    v_mul_f32 v20, s3, v20
    v_mul_f32 v21, s3, v21
    v_cvt_pk_bf16_f32 v20, v20, v21
    v_accvgpr_write_b32 a70, v20
    v_lshlrev_b32 v20, 16, v19
    v_and_b32 v21, 0xffff0000, v19
    v_mul_f32 v20, s3, v20
    v_mul_f32 v21, s3, v21
    v_cvt_pk_bf16_f32 v20, v20, v21
    v_accvgpr_write_b32 a71, v20
    ds_read_b64_tr_b16 v[16:17], v4 offset:32896
    ds_read_b64_tr_b16 v[18:19], v4 offset:33920
    s_waitcnt lgkmcnt(0)
    v_lshlrev_b32 v20, 16, v16
    v_and_b32 v21, 0xffff0000, v16
    v_mul_f32 v20, s3, v20
    v_mul_f32 v21, s3, v21
    v_cvt_pk_bf16_f32 v20, v20, v21
    v_accvgpr_write_b32 a72, v20
    v_lshlrev_b32 v20, 16, v17
    v_and_b32 v21, 0xffff0000, v17
    v_mul_f32 v20, s3, v20
    v_mul_f32 v21, s3, v21
    v_cvt_pk_bf16_f32 v20, v20, v21
    v_accvgpr_write_b32 a73, v20
    v_lshlrev_b32 v20, 16, v18
    v_and_b32 v21, 0xffff0000, v18
    v_mul_f32 v20, s3, v20
    v_mul_f32 v21, s3, v21
    v_cvt_pk_bf16_f32 v20, v20, v21
    v_accvgpr_write_b32 a74, v20
    v_lshlrev_b32 v20, 16, v19
    v_and_b32 v21, 0xffff0000, v19
    v_mul_f32 v20, s3, v20
    v_mul_f32 v21, s3, v21
    v_cvt_pk_bf16_f32 v20, v20, v21
    v_accvgpr_write_b32 a75, v20
    ds_read_b64_tr_b16 v[16:17], v4 offset:32960
    ds_read_b64_tr_b16 v[18:19], v4 offset:33984
    s_waitcnt lgkmcnt(0)
    v_lshlrev_b32 v20, 16, v16
    v_and_b32 v21, 0xffff0000, v16
    v_mul_f32 v20, s3, v20
    v_mul_f32 v21, s3, v21
    v_cvt_pk_bf16_f32 v20, v20, v21
    v_accvgpr_write_b32 a76, v20
    v_lshlrev_b32 v20, 16, v17
    v_and_b32 v21, 0xffff0000, v17
    v_mul_f32 v20, s3, v20
    v_mul_f32 v21, s3, v21
    v_cvt_pk_bf16_f32 v20, v20, v21
    v_accvgpr_write_b32 a77, v20
    v_lshlrev_b32 v20, 16, v18
    v_and_b32 v21, 0xffff0000, v18
    v_mul_f32 v20, s3, v20
    v_mul_f32 v21, s3, v21
    v_cvt_pk_bf16_f32 v20, v20, v21
    v_accvgpr_write_b32 a78, v20
    v_lshlrev_b32 v20, 16, v19
    v_and_b32 v21, 0xffff0000, v19
    v_mul_f32 v20, s3, v20
    v_mul_f32 v21, s3, v21
    v_cvt_pk_bf16_f32 v20, v20, v21
    v_accvgpr_write_b32 a79, v20
    s_barrier
    v_lshlrev_b32 v3, 4, v0
    v_mov_b32 v4, 0
    v_mov_b32 v5, 0
    v_mov_b32 v6, 0
    v_mov_b32 v7, 0
    ds_write_b128 v3, v[4:7] offset:27904
    ds_write_b128 v3, v[4:7] offset:36096
    v_cmp_gt_u32 vcc, 296, v0
    s_mov_b64 exec, vcc
    ds_write_b128 v3, v[4:7] offset:44288
    s_mov_b64 exec, -1
    v_lshlrev_b32 v2, 2, v1
    ds_write_b32 v2, v4 offset:512
    s_load_dwordx4 s[96:99], s[0:1], 16
    s_mov_b32 s74, 0
    s_mov_b32 s75, 0
    s_waitcnt lgkmcnt(0)
S_pass:
    s_mul_i32 s3, s74, 10000
    v_lshlrev_b32 v3, 4, v0
    v_lshlrev_b32 v12, 2, v0
    v_add_u32 v4, s3, v3
    v_add_u32 v5, s3, v12
    v_add_u32 v5, 8000, v5
    s_mov_b64 exec, s[22:23]
    global_load_dwordx4 v[32:35], v4, s[98:99]
    global_load_dword v36, v5, s[98:99]
    global_load_dwordx4 v[16:19], v4, s[96:97]
    global_load_dword v20, v5, s[96:97]
    s_mov_b64 exec, -1
    v_mov_b32 v4, 0x0800ffff
    v_mov_b32 v5, -1
    v_mov_b32 v6, v4
    v_mov_b32 v7, -1
    ds_write_b128 v3, v[4:7] offset:3200
    ds_write_b128 v3, v[4:7] offset:11392
    ds_write_b128 v3, v[4:7] offset:19584
    v_mov_b32 v4, 0
    v_lshlrev_b32 v10, 2, v1
    ds_write_b32 v10, v4 offset:1536
    v_and_b32 v158, 31, v1
    v_lshrrev_b32 v157, 2, v158
    v_and_b32 v157, 4, v157
    v_lshrrev_b32 v159, 1, v158
    v_and_b32 v159, 2, v159
    v_and_b32 v149, 1, v158
    v_or3_b32 v149, v149, v157, v159
    v_lshlrev_b32 v157, 1, v158
    v_and_b32 v157, 16, v157
    v_lshlrev_b32 v159, 2, v158
    v_and_or_b32 v142, v159, 8, v157
    v_lshrrev_b32 v158, 1, v1
    v_lshrrev_b32 v157, 2, v158
    v_and_b32 v157, 4, v157
    v_lshrrev_b32 v159, 1, v158
    v_and_b32 v159, 2, v159
    v_and_b32 v148, 1, v158
    v_or3_b32 v148, v148, v157, v159
    v_lshlrev_b32 v157, 1, v158
    v_and_b32 v157, 16, v157
    v_lshlrev_b32 v159, 2, v158
    v_and_or_b32 v140, v159, 8, v157
    v_lshrrev_b32 v158, 3, v1
    v_lshrrev_b32 v157, 2, v158
    v_and_b32 v157, 4, v157
    v_lshrrev_b32 v159, 1, v158
    v_and_b32 v159, 2, v159
    v_and_b32 v146, 1, v158
    v_or3_b32 v146, v146, v157, v159
    v_lshlrev_b32 v157, 1, v158
    v_and_b32 v157, 16, v157
    v_lshlrev_b32 v159, 2, v158
    v_and_or_b32 v147, v159, 8, v157
    s_mul_i32 s3, s74, 2500
    v_mov_b32 v11, s3
    v_mov_b32 v13, s3
    s_lshl_b32 s3, s75, 12
    s_or_b32 s3, s3, s73
    s_mov_b32 s30, 0xf0ff
    s_waitcnt vmcnt(0)
    v_and_b32 v4, s30, v32
    v_cmp_eq_u32 vcc, s3, v4
    s_and_b64 s[32:33], vcc, s[22:23]
    v_lshrrev_b32 v32, 8, v32
    v_lshl_or_b32 v16, v32, 26, v16
    v_add_u32 v4, 0, v12
    v_lshl_or_b32 v16, v4, 14, v16
    v_and_b32 v4, s30, v33
    v_cmp_eq_u32 vcc, s3, v4
    s_and_b64 s[34:35], vcc, s[22:23]
    v_lshrrev_b32 v33, 8, v33
    v_lshl_or_b32 v17, v33, 26, v17
    v_add_u32 v4, 1, v12
    v_lshl_or_b32 v17, v4, 14, v17
    v_and_b32 v4, s30, v34
    v_cmp_eq_u32 vcc, s3, v4
    s_and_b64 s[36:37], vcc, s[22:23]
    v_lshrrev_b32 v34, 8, v34
    v_lshl_or_b32 v18, v34, 26, v18
    v_add_u32 v4, 2, v12
    v_lshl_or_b32 v18, v4, 14, v18
    v_and_b32 v4, s30, v35
    v_cmp_eq_u32 vcc, s3, v4
    s_and_b64 s[38:39], vcc, s[22:23]
    v_lshrrev_b32 v35, 8, v35
    v_lshl_or_b32 v19, v35, 26, v19
    v_add_u32 v4, 3, v12
    v_lshl_or_b32 v19, v4, 14, v19
    v_and_b32 v4, s30, v36
    v_cmp_eq_u32 vcc, s3, v4
    s_and_b64 s[40:41], vcc, s[22:23]
    v_lshrrev_b32 v36, 8, v36
    v_lshl_or_b32 v20, v36, 26, v20
    v_add_u32 v4, 2000, v0
    v_lshl_or_b32 v20, v4, 14, v20
    s_mov_b64 s[42:43], 0
    s_mov_b64 s[44:45], 0
    s_mov_b64 s[46:47], 0
    s_waitcnt lgkmcnt(0)
    s_barrier
    v_mov_b32 v4, 0xfc
    v_mov_b32 v5, 8
    s_mov_b32 s30, 0x3fff
    v_and_b32_sdwa v32, v16, v4 dst_sel:DWORD dst_unused:UNUSED_PAD src0_sel:BYTE_3 src1_sel:DWORD
    v_and_b32_sdwa v33, v17, v4 dst_sel:DWORD dst_unused:UNUSED_PAD src0_sel:BYTE_3 src1_sel:DWORD
    v_and_b32_sdwa v34, v18, v4 dst_sel:DWORD dst_unused:UNUSED_PAD src0_sel:BYTE_3 src1_sel:DWORD
    v_and_b32_sdwa v35, v19, v4 dst_sel:DWORD dst_unused:UNUSED_PAD src0_sel:BYTE_3 src1_sel:DWORD
    v_and_b32_sdwa v36, v20, v4 dst_sel:DWORD dst_unused:UNUSED_PAD src0_sel:BYTE_3 src1_sel:DWORD
    v_and_b32_sdwa v37, v21, v4 dst_sel:DWORD dst_unused:UNUSED_PAD src0_sel:BYTE_3 src1_sel:DWORD
    v_and_b32_sdwa v38, v22, v4 dst_sel:DWORD dst_unused:UNUSED_PAD src0_sel:BYTE_3 src1_sel:DWORD
    v_and_b32_sdwa v39, v23, v4 dst_sel:DWORD dst_unused:UNUSED_PAD src0_sel:BYTE_3 src1_sel:DWORD
    s_mov_b64 exec, s[32:33]
    ds_add_rtn_u32 v48, v32, v5 offset:1536
    s_mov_b64 exec, s[34:35]
    ds_add_rtn_u32 v49, v33, v5 offset:1536
    s_mov_b64 exec, s[36:37]
    ds_add_rtn_u32 v50, v34, v5 offset:1536
    s_mov_b64 exec, s[38:39]
    ds_add_rtn_u32 v51, v35, v5 offset:1536
    s_mov_b64 exec, s[40:41]
    ds_add_rtn_u32 v52, v36, v5 offset:1536
    s_mov_b64 exec, s[42:43]
    ds_add_rtn_u32 v53, v37, v5 offset:1536
    s_mov_b64 exec, s[44:45]
    ds_add_rtn_u32 v54, v38, v5 offset:1536
    s_mov_b64 exec, s[46:47]
    ds_add_rtn_u32 v55, v39, v5 offset:1536
    s_mov_b64 exec, -1
    v_bfe_u32 v65, v16, 14, 12
    v_lshlrev_b32 v64, 19, v32
    v_add_u32 v65, v65, v11
    v_and_or_b32 v64, v16, s30, v64
    v_bfe_u32 v67, v17, 14, 12
    v_lshlrev_b32 v66, 19, v33
    v_add_u32 v67, v67, v11
    v_and_or_b32 v66, v17, s30, v66
    v_bfe_u32 v69, v18, 14, 12
    v_lshlrev_b32 v68, 19, v34
    v_add_u32 v69, v69, v11
    v_and_or_b32 v68, v18, s30, v68
    v_bfe_u32 v71, v19, 14, 12
    v_lshlrev_b32 v70, 19, v35
    v_add_u32 v71, v71, v11
    v_and_or_b32 v70, v19, s30, v70
    v_bfe_u32 v73, v20, 14, 12
    v_lshlrev_b32 v72, 19, v36
    v_add_u32 v73, v73, v13
    v_and_or_b32 v72, v20, s30, v72
    v_bfe_u32 v75, v21, 14, 12
    v_lshlrev_b32 v74, 19, v37
    v_add_u32 v75, v75, v13
    v_and_or_b32 v74, v21, s30, v74
    v_bfe_u32 v77, v22, 14, 12
    v_lshlrev_b32 v76, 19, v38
    v_add_u32 v77, v77, v13
    v_and_or_b32 v76, v22, s30, v76
    v_bfe_u32 v79, v23, 14, 12
    v_lshlrev_b32 v78, 19, v39
    v_add_u32 v79, v79, v13
    v_and_or_b32 v78, v23, s30, v78
    s_waitcnt lgkmcnt(0)
    s_barrier
    ds_read_b32 v6, v10 offset:1536
    s_waitcnt lgkmcnt(0)
    v_add_u32 v8, 24, v6
    v_and_b32 v8, 0xffffffe0, v8
    v_mov_b32 v7, v8
    s_nop 1
    v_add_u32_dpp v7, v7, v7 row_shr:1 row_mask:0xf bank_mask:0xf
    s_nop 1
    v_add_u32_dpp v7, v7, v7 row_shr:2 row_mask:0xf bank_mask:0xf
    s_nop 1
    v_add_u32_dpp v7, v7, v7 row_shr:4 row_mask:0xf bank_mask:0xf
    s_nop 1
    v_add_u32_dpp v7, v7, v7 row_shr:8 row_mask:0xf bank_mask:0xf
    s_nop 1
    v_add_u32_dpp v7, v7, v7 row_bcast:15 row_mask:0xa bank_mask:0xf
    s_nop 1
    v_add_u32_dpp v7, v7, v7 row_bcast:31 row_mask:0xc bank_mask:0xf
    v_sub_u32 v8, v7, v8
    v_subrev_u32 v9, 32, v7
    ds_write_b32 v10, v8 offset:1792
    v_readlane_b32 s72, v7, 63
    s_cmp_lg_u32 s24, 0
    s_cbranch_scc1 S_nodeg
    ds_add_u32 v10, v6 offset:512
S_nodeg:
    ds_read_b32 v96, v32 offset:1792
    ds_read_b32 v97, v33 offset:1792
    ds_read_b32 v98, v34 offset:1792
    ds_read_b32 v99, v35 offset:1792
    ds_read_b32 v100, v36 offset:1792
    ds_read_b32 v101, v37 offset:1792
    ds_read_b32 v102, v38 offset:1792
    ds_read_b32 v103, v39 offset:1792
    s_lshr_b32 s72, s72, 5
    s_add_u32 s30, s72, 31
    s_lshr_b32 s30, s30, 5
    s_mul_i32 s70, s30, 42
    s_add_u32 s70, s70, 32
    s_lshr_b32 s70, s70, 6
    s_lshl_b32 s31, s70, 5
    s_sub_i32 s91, s72, s31
    s_max_i32 s91, s91, 0
    s_add_u32 s91, s91, 7
    s_bfe_u32 s100, s91, 0x20003
    s_lshr_b32 s91, s91, 5
    s_add_u32 s71, s91, 1
    s_and_b32 s30, s24, 3
    s_cmp_lt_u32 s30, s100
    s_cselect_b32 s25, s71, s91
    s_min_u32 s90, s30, s100
    s_mul_i32 s65, s30, s91
    s_add_u32 s65, s65, s90
    s_lshl_b32 s65, s65, 3
    s_add_u32 s65, s65, s31
    s_mul_i32 s30, s30, s70
    s_lshl_b32 s30, s30, 3
    s_cmp_lt_u32 s24, 4
    s_cselect_b32 s25, s70, s25
    s_cselect_b32 s65, s30, s65
    s_lshl_b32 s100, s100, 3
    s_mul_i32 s90, s100, s71
    s_add_u32 s90, s90, s31
    s_add_u32 s100, s100, 32
    s_lshl_b32 s30, s25, 5
    s_lshl_b32 s31, s65, 5
    v_mad_u32_u24 v149, v149, s30, v142
    v_add_u32 v149, s31, v149
    v_mad_u32_u24 v148, v148, s30, v140
    v_add_u32 v148, s31, v148
    v_mad_u32_u24 v146, v146, s30, v147
    v_add_u32 v146, s31, v146
    s_lshl_b32 s30, s30, 2
    v_add_u32 v147, s30, v146
    s_waitcnt lgkmcnt(7)
    v_add_u32 v48, v48, v96
    s_mov_b64 exec, s[32:33]
    ds_write_b64 v48, v[64:65] offset:3200
    s_mov_b64 exec, -1
    s_waitcnt lgkmcnt(7)
    v_add_u32 v49, v49, v97
    s_mov_b64 exec, s[34:35]
    ds_write_b64 v49, v[66:67] offset:3200
    s_mov_b64 exec, -1
    s_waitcnt lgkmcnt(7)
    v_add_u32 v50, v50, v98
    s_mov_b64 exec, s[36:37]
    ds_write_b64 v50, v[68:69] offset:3200
    s_mov_b64 exec, -1
    s_waitcnt lgkmcnt(7)
    v_add_u32 v51, v51, v99
    s_mov_b64 exec, s[38:39]
    ds_write_b64 v51, v[70:71] offset:3200
    s_mov_b64 exec, -1
    s_waitcnt lgkmcnt(7)
    v_add_u32 v52, v52, v100
    s_mov_b64 exec, s[40:41]
    ds_write_b64 v52, v[72:73] offset:3200
    s_mov_b64 exec, -1
    s_waitcnt lgkmcnt(7)
    v_add_u32 v53, v53, v101
    s_mov_b64 exec, s[42:43]
    ds_write_b64 v53, v[74:75] offset:3200
    s_mov_b64 exec, -1
    s_waitcnt lgkmcnt(7)
    v_add_u32 v54, v54, v102
    s_mov_b64 exec, s[44:45]
    ds_write_b64 v54, v[76:77] offset:3200
    s_mov_b64 exec, -1
    s_waitcnt lgkmcnt(7)
    v_add_u32 v55, v55, v103
    s_mov_b64 exec, s[46:47]
    ds_write_b64 v55, v[78:79] offset:3200
    s_mov_b64 exec, -1
    s_waitcnt lgkmcnt(0)
    s_barrier
    s_sub_u32 s26, s25, 1
    v_cmp_ne_u32 vcc, 0, v6
    v_bfrev_b32 v2, 1
    ds_read_b32 v140, v148 offset:3204
    ds_read_u16 v132, v146 offset:3200
    ds_read_u16 v134, v146 offset:3216
    ds_read_u16 v136, v147 offset:3200
    ds_read_u16 v138, v147 offset:3216
    s_mov_b64 exec, vcc
    ds_or_b32 v9, v2 offset:3200
    s_mov_b64 exec, -1
    ds_read_u16 v142, v149 offset:3202
    s_cmp_gt_u32 s25, 0
    s_cselect_b32 s6, 10000, 0
    s_cselect_b32 s10, 640000, 0
    s_waitcnt lgkmcnt(2)
    s_add_u32 m0, s27, 4096
    s_nop 0
    buffer_load_dwordx4 v[140:141], s[8:11], 0 idxen offen lds
    s_add_u32 m0, s27, 0
    s_nop 0
    buffer_load_dwordx4 v[132:133], s[4:7], 0 idxen offen offset:0 lds
    buffer_load_dwordx4 v[134:135], s[4:7], 0 idxen offen offset:1024 lds
    buffer_load_dwordx4 v[136:137], s[4:7], 0 idxen offen offset:2048 lds
    buffer_load_dwordx4 v[138:139], s[4:7], 0 idxen offen offset:3072 lds
    s_lshl_b32 s30, s65, 5
    v_cmp_ge_u32 vcc, s30, v7
    s_bcnt1_i32_b64 s76, vcc
    s_lshr_b32 s30, s76, 4
    s_min_u32 s30, s30, 2
    s_lshl_b32 s30, s30, 5
    s_add_u32 s31, s30, 32
    s_min_u32 s31, s31, 64
    v_and_b32 v2, 31, v1
    v_mul_u32_u24 v2, 112, v2
    v_lshrrev_b32 v4, 0, v155
    v_add3_u32 v3, v2, v4, s31
    v_add3_u32 v2, v2, v4, s30
    ds_read_b128 v[88:91], v2 offset:49024
    ds_read_b128 v[32:35], v3 offset:49024
    ds_read_b128 v[92:95], v2 offset:52608
    ds_read_b128 v[36:39], v3 offset:52608
    ds_read_b128 v[96:99], v2 offset:56192
    ds_read_b128 v[40:43], v3 offset:56192
    ds_read_b128 v[100:103], v2 offset:59776
    ds_read_b128 v[44:47], v3 offset:59776
    s_and_b32 s76, s76, 15
    v_lshrrev_b32 v3, 1, v4
    v_sub_u32 v3, s76, v3
    v_mov_b32 v4, 0xffff
    v_cmp_lt_i32 s[78:79], 0, v3
    v_cmp_lt_i32 s[80:81], 1, v3
    s_nop 0
    v_cndmask_b32 v48, 0, v4, s[78:79]
    v_cndmask_b32 v48, v48, -1, s[80:81]
    v_cmp_lt_i32 s[78:79], 2, v3
    v_cmp_lt_i32 s[80:81], 3, v3
    s_nop 0
    v_cndmask_b32 v49, 0, v4, s[78:79]
    v_cndmask_b32 v49, v49, -1, s[80:81]
    v_cmp_lt_i32 s[78:79], 4, v3
    v_cmp_lt_i32 s[80:81], 5, v3
    s_nop 0
    v_cndmask_b32 v50, 0, v4, s[78:79]
    v_cndmask_b32 v50, v50, -1, s[80:81]
    v_cmp_lt_i32 s[78:79], 6, v3
    v_cmp_lt_i32 s[80:81], 7, v3
    s_nop 0
    v_cndmask_b32 v51, 0, v4, s[78:79]
    v_cndmask_b32 v51, v51, -1, s[80:81]
    s_waitcnt lgkmcnt(0)
    v_bfi_b32 v88, v48, v32, v88
    v_bfi_b32 v89, v49, v33, v89
    v_bfi_b32 v90, v50, v34, v90
    v_bfi_b32 v91, v51, v35, v91
    v_bfi_b32 v92, v48, v36, v92
    v_bfi_b32 v93, v49, v37, v93
    v_bfi_b32 v94, v50, v38, v94
    v_bfi_b32 v95, v51, v39, v95
    v_bfi_b32 v96, v48, v40, v96
    v_bfi_b32 v97, v49, v41, v97
    v_bfi_b32 v98, v50, v42, v98
    v_bfi_b32 v99, v51, v43, v99
    v_bfi_b32 v100, v48, v44, v100
    v_bfi_b32 v101, v49, v45, v101
    v_bfi_b32 v102, v50, v46, v102
    v_bfi_b32 v103, v51, v47, v103
    v_cvt_f32_u32 v4, s70
    v_cvt_f32_u32 v5, s71
    v_cvt_f32_u32 v3, s91
    v_rcp_f32 v4, v4
    v_rcp_f32 v5, v5
    v_rcp_f32 v3, v3
    s_lshl_b32 s30, s70, 5
    v_lshrrev_b32 v10, 5, v8
    v_subrev_u32 v11, s30, v10
    v_subrev_u32 v157, s90, v10
    v_cmp_gt_u32 vcc, s30, v10
    v_cmp_gt_u32 s[78:79], s90, v10
    v_cvt_f32_u32 v10, v10
    v_cvt_f32_i32 v11, v11
    v_cvt_f32_i32 v157, v157
    v_add_f32 v10, 0.5, v10
    v_add_f32 v11, 0.5, v11
    v_add_f32 v157, 0.5, v157
    v_mul_f32 v10, v10, v4
    v_mul_f32 v11, v11, v5
    v_mul_f32 v157, v157, v3
    v_cvt_u32_f32 v10, v10
    v_cvt_u32_f32 v11, v11
    v_cvt_u32_f32 v157, v157
    v_min_u32 v157, 32, v157
    v_add_u32 v11, 32, v11
    v_add_u32 v157, s100, v157
    v_min_u32 v157, 64, v157
    v_cndmask_b32 v11, v157, v11, s[78:79]
    v_cndmask_b32 v12, v11, v10, vcc
    v_lshrrev_b32 v10, 5, v7
    v_subrev_u32 v11, s30, v10
    v_subrev_u32 v157, s90, v10
    v_cmp_gt_u32 vcc, s30, v10
    v_cmp_gt_u32 s[78:79], s90, v10
    v_cvt_f32_u32 v10, v10
    v_cvt_f32_i32 v11, v11
    v_cvt_f32_i32 v157, v157
    v_add_f32 v10, 0.5, v10
    v_add_f32 v11, 0.5, v11
    v_add_f32 v157, 0.5, v157
    v_mul_f32 v10, v10, v4
    v_mul_f32 v11, v11, v5
    v_mul_f32 v157, v157, v3
    v_cvt_u32_f32 v10, v10
    v_cvt_u32_f32 v11, v11
    v_cvt_u32_f32 v157, v157
    v_min_u32 v157, 32, v157
    v_add_u32 v11, 32, v11
    v_add_u32 v157, s100, v157
    v_min_u32 v157, 64, v157
    v_cndmask_b32 v11, v157, v11, s[78:79]
    v_cndmask_b32 v13, v11, v10, vcc
    v_lshl_or_b32 v15, v13, 8, v12
    ds_read_b32 v140, v148 offset:3236
    ds_read_u16 v132, v146 offset:3232
    ds_read_u16 v134, v146 offset:3248
    ds_read_u16 v136, v147 offset:3232
    ds_read_u16 v138, v147 offset:3248
    v_and_or_b32 v144, v142, s64, v155
    v_pk_mov_b32 v[104:105], 0, 0
    v_pk_mov_b32 v[106:107], 0, 0
    v_pk_mov_b32 v[108:109], 0, 0
    v_pk_mov_b32 v[110:111], 0, 0
    v_pk_mov_b32 v[112:113], 0, 0
    v_pk_mov_b32 v[114:115], 0, 0
    v_pk_mov_b32 v[116:117], 0, 0
    v_pk_mov_b32 v[118:119], 0, 0
    v_pk_mov_b32 v[120:121], 0, 0
    v_pk_mov_b32 v[122:123], 0, 0
    v_mov_b32 v124, 1.0
    v_mov_b32 v125, 1.0
    v_mov_b32 v126, 1.0
    v_mov_b32 v127, 1.0
    v_cmp_eq_u32 vcc, 2, v1
    v_mov_b32 v2, 0x8000
    s_cmp_gt_u32 s25, 1
    s_cselect_b32 s6, 10000, 0
    s_cselect_b32 s10, 640000, 0
    v_cndmask_b32 v143, 0, v2, vcc
    s_waitcnt vmcnt(0)
    ds_read_b128 v[64:67], v150 offset:0
    ds_read_b128 v[68:71], v151 offset:0
    ds_read_b128 v[72:75], v152 offset:0
    ds_read_b128 v[76:79], v153 offset:0
    ds_read_b128 v[80:83], v154 offset:0
    ds_read_b128 v[84:87], v144 offset:0
    s_waitcnt lgkmcnt(5)
    v_mfma_f32_32x32x16_bf16 v[16:31], v[64:67], a[0:3], 0
    s_waitcnt lgkmcnt(4)
    v_mfma_f32_32x32x16_bf16 v[16:31], v[68:71], a[16:19], v[16:31]
    s_waitcnt lgkmcnt(3)
    v_mfma_f32_32x32x16_bf16 v[16:31], v[72:75], a[32:35], v[16:31]
    s_waitcnt lgkmcnt(2)
    v_mfma_f32_32x32x16_bf16 v[16:31], v[76:79], a[48:51], v[16:31]
    s_waitcnt lgkmcnt(1)
    v_mfma_f32_32x32x16_bf16 v[16:31], v[80:83], a[64:67], v[16:31]
    s_waitcnt lgkmcnt(0)
    v_mfma_f32_32x32x16_bf16 v[16:31], v[84:87], v[88:91], v[16:31]
    s_add_u32 m0, s27, 9216
    s_nop 0
    buffer_load_dwordx4 v[140:141], s[8:11], 0 idxen offen lds
    s_add_u32 m0, s27, 5120
    s_nop 0
    buffer_load_dwordx4 v[132:133], s[4:7], 0 idxen offen offset:0 lds
    buffer_load_dwordx4 v[134:135], s[4:7], 0 idxen offen offset:1024 lds
    buffer_load_dwordx4 v[136:137], s[4:7], 0 idxen offen offset:2048 lds
    buffer_load_dwordx4 v[138:139], s[4:7], 0 idxen offen offset:3072 lds
    ds_read_b32 v140, v148 offset:3268
    ds_read_u16 v132, v146 offset:3264
    ds_read_u16 v134, v146 offset:3280
    ds_read_u16 v136, v147 offset:3264
    ds_read_u16 v138, v147 offset:3280
    s_cmp_eq_u32 s25, 0
    s_cbranch_scc1 S_tail1
S_it0:
    v_mfma_f32_32x32x16_bf16 v[32:47], v[64:67], a[4:7], 0
    v_exp_f32 v48, v16
    v_exp_f32 v49, v17
    v_exp_f32 v56, v24
    v_mfma_f32_32x32x16_bf16 v[32:47], v[68:71], a[20:23], v[32:47]
    v_exp_f32 v57, v25
    v_exp_f32 v50, v18
    v_exp_f32 v51, v19
    v_mfma_f32_32x32x16_bf16 v[32:47], v[72:75], a[36:39], v[32:47]
    v_exp_f32 v58, v26
    v_exp_f32 v59, v27
    v_exp_f32 v52, v20
    v_mfma_f32_32x32x16_bf16 v[32:47], v[76:79], a[52:55], v[32:47]
    v_exp_f32 v53, v21
    v_exp_f32 v60, v28
    v_exp_f32 v61, v29
    v_mfma_f32_32x32x16_bf16 v[32:47], v[80:83], a[68:71], v[32:47]
    v_exp_f32 v54, v22
    v_exp_f32 v55, v23
    v_exp_f32 v62, v30
    v_mfma_f32_32x32x16_bf16 v[32:47], v[84:87], v[92:95], v[32:47]
    v_exp_f32 v63, v31
    s_nop 0
    v_cmp_gt_i16 vcc, 0, v143
    s_cbranch_vccnz S_fl0
S_flr0:
    ds_read_u16 v143, v149 offset:3234
    ds_read_b32 v140, v148 offset:3300
    ds_read_u16 v132, v146 offset:3296
    ds_read_u16 v134, v146 offset:3312
    ds_read_u16 v136, v147 offset:3296
    ds_read_u16 v138, v147 offset:3312
    v_pk_add_f32 v[48:49], v[48:49], 1.0 op_sel_hi:[1,0]
    v_pk_add_f32 v[50:51], v[50:51], 1.0 op_sel_hi:[1,0]
    v_pk_add_f32 v[52:53], v[52:53], 1.0 op_sel_hi:[1,0]
    v_pk_add_f32 v[54:55], v[54:55], 1.0 op_sel_hi:[1,0]
    v_pk_add_f32 v[56:57], v[56:57], 1.0 op_sel_hi:[1,0]
    v_pk_add_f32 v[58:59], v[58:59], 1.0 op_sel_hi:[1,0]
    v_pk_add_f32 v[60:61], v[60:61], 1.0 op_sel_hi:[1,0]
    v_pk_add_f32 v[62:63], v[62:63], 1.0 op_sel_hi:[1,0]
    v_rcp_f32 v48, v48
    v_rcp_f32 v49, v49
    v_rcp_f32 v50, v50
    v_rcp_f32 v51, v51
    v_rcp_f32 v52, v52
    v_rcp_f32 v53, v53
    v_rcp_f32 v54, v54
    v_rcp_f32 v55, v55
    v_rcp_f32 v56, v56
    v_rcp_f32 v57, v57
    v_rcp_f32 v58, v58
    v_rcp_f32 v59, v59
    v_rcp_f32 v60, v60
    v_rcp_f32 v61, v61
    v_rcp_f32 v62, v62
    v_rcp_f32 v63, v63
    s_nop 0
    v_pk_fma_f32 v[104:105], v[16:17], v[48:49], v[104:105]
    v_pk_fma_f32 v[106:107], v[24:25], v[56:57], v[106:107]
    v_pk_fma_f32 v[104:105], v[18:19], v[50:51], v[104:105]
    v_pk_fma_f32 v[106:107], v[26:27], v[58:59], v[106:107]
    v_pk_fma_f32 v[104:105], v[20:21], v[52:53], v[104:105]
    v_pk_fma_f32 v[106:107], v[28:29], v[60:61], v[106:107]
    v_pk_fma_f32 v[104:105], v[22:23], v[54:55], v[104:105]
    v_pk_fma_f32 v[106:107], v[30:31], v[62:63], v[106:107]
    v_mfma_f32_32x32x16_bf16 v[16:31], v[64:67], a[8:11], 0
    v_exp_f32 v48, v32
    v_exp_f32 v49, v33
    v_exp_f32 v56, v40
    v_mfma_f32_32x32x16_bf16 v[16:31], v[68:71], a[24:27], v[16:31]
    v_exp_f32 v57, v41
    v_exp_f32 v50, v34
    v_exp_f32 v51, v35
    v_mfma_f32_32x32x16_bf16 v[16:31], v[72:75], a[40:43], v[16:31]
    v_exp_f32 v58, v42
    v_exp_f32 v59, v43
    v_exp_f32 v52, v36
    v_mfma_f32_32x32x16_bf16 v[16:31], v[76:79], a[56:59], v[16:31]
    v_exp_f32 v53, v37
    v_exp_f32 v60, v44
    v_exp_f32 v61, v45
    v_mfma_f32_32x32x16_bf16 v[16:31], v[80:83], a[72:75], v[16:31]
    v_exp_f32 v54, v38
    v_exp_f32 v55, v39
    v_exp_f32 v62, v46
    v_mfma_f32_32x32x16_bf16 v[16:31], v[84:87], v[96:99], v[16:31]
    v_exp_f32 v63, v47
    s_nop 0
    v_pk_add_f32 v[48:49], v[48:49], 1.0 op_sel_hi:[1,0]
    v_pk_add_f32 v[50:51], v[50:51], 1.0 op_sel_hi:[1,0]
    v_pk_add_f32 v[52:53], v[52:53], 1.0 op_sel_hi:[1,0]
    v_pk_add_f32 v[54:55], v[54:55], 1.0 op_sel_hi:[1,0]
    v_pk_add_f32 v[56:57], v[56:57], 1.0 op_sel_hi:[1,0]
    v_pk_add_f32 v[58:59], v[58:59], 1.0 op_sel_hi:[1,0]
    v_pk_add_f32 v[60:61], v[60:61], 1.0 op_sel_hi:[1,0]
    v_pk_add_f32 v[62:63], v[62:63], 1.0 op_sel_hi:[1,0]
    v_rcp_f32 v48, v48
    v_rcp_f32 v49, v49
    v_rcp_f32 v50, v50
    v_rcp_f32 v51, v51
    v_rcp_f32 v52, v52
    v_rcp_f32 v53, v53
    v_rcp_f32 v54, v54
    v_rcp_f32 v55, v55
    v_rcp_f32 v56, v56
    v_rcp_f32 v57, v57
    v_rcp_f32 v58, v58
    v_rcp_f32 v59, v59
    v_rcp_f32 v60, v60
    v_rcp_f32 v61, v61
    v_rcp_f32 v62, v62
    v_rcp_f32 v63, v63
    s_nop 0
    v_pk_fma_f32 v[108:109], v[32:33], v[48:49], v[108:109]
    v_pk_fma_f32 v[110:111], v[40:41], v[56:57], v[110:111]
    v_pk_fma_f32 v[108:109], v[34:35], v[50:51], v[108:109]
    v_pk_fma_f32 v[110:111], v[42:43], v[58:59], v[110:111]
    v_pk_fma_f32 v[108:109], v[36:37], v[52:53], v[108:109]
    v_pk_fma_f32 v[110:111], v[44:45], v[60:61], v[110:111]
    v_pk_fma_f32 v[108:109], v[38:39], v[54:55], v[108:109]
    v_pk_fma_f32 v[110:111], v[46:47], v[62:63], v[110:111]
    v_mfma_f32_32x32x16_bf16 v[32:47], v[64:67], a[12:15], 0
    v_exp_f32 v48, v16
    v_exp_f32 v49, v17
    v_exp_f32 v56, v24
    v_mfma_f32_32x32x16_bf16 v[32:47], v[68:71], a[28:31], v[32:47]
    v_exp_f32 v57, v25
    v_exp_f32 v50, v18
    v_exp_f32 v51, v19
    v_mfma_f32_32x32x16_bf16 v[32:47], v[72:75], a[44:47], v[32:47]
    v_exp_f32 v58, v26
    v_exp_f32 v59, v27
    v_exp_f32 v52, v20
    v_mfma_f32_32x32x16_bf16 v[32:47], v[76:79], a[60:63], v[32:47]
    v_exp_f32 v53, v21
    v_exp_f32 v60, v28
    v_exp_f32 v61, v29
    v_mfma_f32_32x32x16_bf16 v[32:47], v[80:83], a[76:79], v[32:47]
    v_exp_f32 v54, v22
    v_exp_f32 v55, v23
    v_exp_f32 v62, v30
    v_mfma_f32_32x32x16_bf16 v[32:47], v[84:87], v[100:103], v[32:47]
    v_exp_f32 v63, v31
    s_nop 0
    s_sub_u32 s26, s26, 1
    s_cbranch_scc1 S_last0
    s_waitcnt vmcnt(5) lgkmcnt(0)
    v_and_or_b32 v144, v143, s64, v155
    ds_read_b128 v[64:67], v150 offset:5120
    ds_read_b128 v[68:71], v151 offset:5120
    ds_read_b128 v[72:75], v152 offset:5120
    ds_read_b128 v[76:79], v153 offset:5120
    ds_read_b128 v[80:83], v154 offset:5120
    ds_read_b128 v[84:87], v144 offset:0
    v_pk_add_f32 v[48:49], v[48:49], 1.0 op_sel_hi:[1,0]
    v_pk_add_f32 v[50:51], v[50:51], 1.0 op_sel_hi:[1,0]
    v_pk_add_f32 v[52:53], v[52:53], 1.0 op_sel_hi:[1,0]
    v_pk_add_f32 v[54:55], v[54:55], 1.0 op_sel_hi:[1,0]
    v_pk_add_f32 v[56:57], v[56:57], 1.0 op_sel_hi:[1,0]
    v_pk_add_f32 v[58:59], v[58:59], 1.0 op_sel_hi:[1,0]
    v_pk_add_f32 v[60:61], v[60:61], 1.0 op_sel_hi:[1,0]
    v_pk_add_f32 v[62:63], v[62:63], 1.0 op_sel_hi:[1,0]
    v_rcp_f32 v48, v48
    v_rcp_f32 v49, v49
    v_rcp_f32 v50, v50
    v_rcp_f32 v51, v51
    v_rcp_f32 v52, v52
    v_rcp_f32 v53, v53
    v_rcp_f32 v54, v54
    v_rcp_f32 v55, v55
    v_rcp_f32 v56, v56
    v_rcp_f32 v57, v57
    v_rcp_f32 v58, v58
    v_rcp_f32 v59, v59
    v_rcp_f32 v60, v60
    v_rcp_f32 v61, v61
    v_rcp_f32 v62, v62
    v_rcp_f32 v63, v63
    s_nop 0
    v_pk_fma_f32 v[112:113], v[16:17], v[48:49], v[112:113]
    v_pk_fma_f32 v[114:115], v[24:25], v[56:57], v[114:115]
    v_pk_fma_f32 v[112:113], v[18:19], v[50:51], v[112:113]
    v_pk_fma_f32 v[114:115], v[26:27], v[58:59], v[114:115]
    v_pk_fma_f32 v[112:113], v[20:21], v[52:53], v[112:113]
    v_pk_fma_f32 v[114:115], v[28:29], v[60:61], v[114:115]
    v_pk_fma_f32 v[112:113], v[22:23], v[54:55], v[112:113]
    v_pk_fma_f32 v[114:115], v[30:31], v[62:63], v[114:115]
    s_waitcnt lgkmcnt(0)
    v_mfma_f32_32x32x16_bf16 v[16:31], v[64:67], a[0:3], 0
    v_exp_f32 v48, v32
    v_exp_f32 v49, v33
    v_exp_f32 v56, v40
    v_mfma_f32_32x32x16_bf16 v[16:31], v[68:71], a[16:19], v[16:31]
    v_exp_f32 v57, v41
    v_exp_f32 v50, v34
    v_exp_f32 v51, v35
    v_mfma_f32_32x32x16_bf16 v[16:31], v[72:75], a[32:35], v[16:31]
    v_exp_f32 v58, v42
    v_exp_f32 v59, v43
    v_exp_f32 v52, v36
    v_mfma_f32_32x32x16_bf16 v[16:31], v[76:79], a[48:51], v[16:31]
    v_exp_f32 v53, v37
    v_exp_f32 v60, v44
    v_exp_f32 v61, v45
    v_mfma_f32_32x32x16_bf16 v[16:31], v[80:83], a[64:67], v[16:31]
    v_exp_f32 v54, v38
    v_exp_f32 v55, v39
    v_exp_f32 v62, v46
    v_mfma_f32_32x32x16_bf16 v[16:31], v[84:87], v[88:91], v[16:31]
    v_exp_f32 v63, v47
    s_nop 0
    s_cmp_gt_u32 s26, 1
    s_cselect_b32 s6, 10000, 0
    s_cselect_b32 s10, 640000, 0
    s_add_u32 m0, s27, 9216
    s_nop 0
    buffer_load_dwordx4 v[140:141], s[8:11], 0 idxen offen lds
    s_add_u32 m0, s27, 5120
    s_nop 0
    buffer_load_dwordx4 v[132:133], s[4:7], 0 idxen offen offset:0 lds
    buffer_load_dwordx4 v[134:135], s[4:7], 0 idxen offen offset:1024 lds
    buffer_load_dwordx4 v[136:137], s[4:7], 0 idxen offen offset:2048 lds
    buffer_load_dwordx4 v[138:139], s[4:7], 0 idxen offen offset:3072 lds
    v_pk_add_f32 v[48:49], v[48:49], 1.0 op_sel_hi:[1,0]
    v_pk_add_f32 v[50:51], v[50:51], 1.0 op_sel_hi:[1,0]
    v_pk_add_f32 v[52:53], v[52:53], 1.0 op_sel_hi:[1,0]
    v_pk_add_f32 v[54:55], v[54:55], 1.0 op_sel_hi:[1,0]
    v_pk_add_f32 v[56:57], v[56:57], 1.0 op_sel_hi:[1,0]
    v_pk_add_f32 v[58:59], v[58:59], 1.0 op_sel_hi:[1,0]
    v_pk_add_f32 v[60:61], v[60:61], 1.0 op_sel_hi:[1,0]
    v_pk_add_f32 v[62:63], v[62:63], 1.0 op_sel_hi:[1,0]
    v_rcp_f32 v48, v48
    v_rcp_f32 v49, v49
    v_rcp_f32 v50, v50
    v_rcp_f32 v51, v51
    v_rcp_f32 v52, v52
    v_rcp_f32 v53, v53
    v_rcp_f32 v54, v54
    v_rcp_f32 v55, v55
    v_rcp_f32 v56, v56
    v_rcp_f32 v57, v57
    v_rcp_f32 v58, v58
    v_rcp_f32 v59, v59
    v_rcp_f32 v60, v60
    v_rcp_f32 v61, v61
    v_rcp_f32 v62, v62
    v_rcp_f32 v63, v63
    s_nop 0
    v_pk_fma_f32 v[116:117], v[32:33], v[48:49], v[116:117]
    v_pk_fma_f32 v[118:119], v[40:41], v[56:57], v[118:119]
    v_pk_fma_f32 v[116:117], v[34:35], v[50:51], v[116:117]
    v_pk_fma_f32 v[118:119], v[42:43], v[58:59], v[118:119]
    v_pk_fma_f32 v[116:117], v[36:37], v[52:53], v[116:117]
    v_pk_fma_f32 v[118:119], v[44:45], v[60:61], v[118:119]
    v_pk_fma_f32 v[116:117], v[38:39], v[54:55], v[116:117]
    v_pk_fma_f32 v[118:119], v[46:47], v[62:63], v[118:119]
S_it1:
    v_mfma_f32_32x32x16_bf16 v[32:47], v[64:67], a[4:7], 0
    v_exp_f32 v48, v16
    v_exp_f32 v49, v17
    v_exp_f32 v56, v24
    v_mfma_f32_32x32x16_bf16 v[32:47], v[68:71], a[20:23], v[32:47]
    v_exp_f32 v57, v25
    v_exp_f32 v50, v18
    v_exp_f32 v51, v19
    v_mfma_f32_32x32x16_bf16 v[32:47], v[72:75], a[36:39], v[32:47]
    v_exp_f32 v58, v26
    v_exp_f32 v59, v27
    v_exp_f32 v52, v20
    v_mfma_f32_32x32x16_bf16 v[32:47], v[76:79], a[52:55], v[32:47]
    v_exp_f32 v53, v21
    v_exp_f32 v60, v28
    v_exp_f32 v61, v29
    v_mfma_f32_32x32x16_bf16 v[32:47], v[80:83], a[68:71], v[32:47]
    v_exp_f32 v54, v22
    v_exp_f32 v55, v23
    v_exp_f32 v62, v30
    v_mfma_f32_32x32x16_bf16 v[32:47], v[84:87], v[92:95], v[32:47]
    v_exp_f32 v63, v31
    s_nop 0
    v_cmp_gt_i16 vcc, 0, v142
    s_cbranch_vccnz S_fl1
S_flr1:
    ds_read_u16 v142, v149 offset:3266
    ds_read_b32 v140, v148 offset:3332
    ds_read_u16 v132, v146 offset:3328
    ds_read_u16 v134, v146 offset:3344
    ds_read_u16 v136, v147 offset:3328
    ds_read_u16 v138, v147 offset:3344
    v_pk_add_f32 v[48:49], v[48:49], 1.0 op_sel_hi:[1,0]
    v_pk_add_f32 v[50:51], v[50:51], 1.0 op_sel_hi:[1,0]
    v_pk_add_f32 v[52:53], v[52:53], 1.0 op_sel_hi:[1,0]
    v_pk_add_f32 v[54:55], v[54:55], 1.0 op_sel_hi:[1,0]
    v_pk_add_f32 v[56:57], v[56:57], 1.0 op_sel_hi:[1,0]
    v_pk_add_f32 v[58:59], v[58:59], 1.0 op_sel_hi:[1,0]
    v_pk_add_f32 v[60:61], v[60:61], 1.0 op_sel_hi:[1,0]
    v_pk_add_f32 v[62:63], v[62:63], 1.0 op_sel_hi:[1,0]
    v_rcp_f32 v48, v48
    v_rcp_f32 v49, v49
    v_rcp_f32 v50, v50
    v_rcp_f32 v51, v51
    v_rcp_f32 v52, v52
    v_rcp_f32 v53, v53
    v_rcp_f32 v54, v54
    v_rcp_f32 v55, v55
    v_rcp_f32 v56, v56
    v_rcp_f32 v57, v57
    v_rcp_f32 v58, v58
    v_rcp_f32 v59, v59
    v_rcp_f32 v60, v60
    v_rcp_f32 v61, v61
    v_rcp_f32 v62, v62
    v_rcp_f32 v63, v63
    s_nop 0
    v_pk_fma_f32 v[104:105], v[16:17], v[48:49], v[104:105]
    v_pk_fma_f32 v[106:107], v[24:25], v[56:57], v[106:107]
    v_pk_fma_f32 v[104:105], v[18:19], v[50:51], v[104:105]
    v_pk_fma_f32 v[106:107], v[26:27], v[58:59], v[106:107]
    v_pk_fma_f32 v[104:105], v[20:21], v[52:53], v[104:105]
    v_pk_fma_f32 v[106:107], v[28:29], v[60:61], v[106:107]
    v_pk_fma_f32 v[104:105], v[22:23], v[54:55], v[104:105]
    v_pk_fma_f32 v[106:107], v[30:31], v[62:63], v[106:107]
    v_mfma_f32_32x32x16_bf16 v[16:31], v[64:67], a[8:11], 0
    v_exp_f32 v48, v32
    v_exp_f32 v49, v33
    v_exp_f32 v56, v40
    v_mfma_f32_32x32x16_bf16 v[16:31], v[68:71], a[24:27], v[16:31]
    v_exp_f32 v57, v41
    v_exp_f32 v50, v34
    v_exp_f32 v51, v35
    v_mfma_f32_32x32x16_bf16 v[16:31], v[72:75], a[40:43], v[16:31]
    v_exp_f32 v58, v42
    v_exp_f32 v59, v43
    v_exp_f32 v52, v36
    v_mfma_f32_32x32x16_bf16 v[16:31], v[76:79], a[56:59], v[16:31]
    v_exp_f32 v53, v37
    v_exp_f32 v60, v44
    v_exp_f32 v61, v45
    v_mfma_f32_32x32x16_bf16 v[16:31], v[80:83], a[72:75], v[16:31]
    v_exp_f32 v54, v38
    v_exp_f32 v55, v39
    v_exp_f32 v62, v46
    v_mfma_f32_32x32x16_bf16 v[16:31], v[84:87], v[96:99], v[16:31]
    v_exp_f32 v63, v47
    s_nop 0
    v_pk_add_f32 v[48:49], v[48:49], 1.0 op_sel_hi:[1,0]
    v_pk_add_f32 v[50:51], v[50:51], 1.0 op_sel_hi:[1,0]
    v_pk_add_f32 v[52:53], v[52:53], 1.0 op_sel_hi:[1,0]
    v_pk_add_f32 v[54:55], v[54:55], 1.0 op_sel_hi:[1,0]
    v_pk_add_f32 v[56:57], v[56:57], 1.0 op_sel_hi:[1,0]
    v_pk_add_f32 v[58:59], v[58:59], 1.0 op_sel_hi:[1,0]
    v_pk_add_f32 v[60:61], v[60:61], 1.0 op_sel_hi:[1,0]
    v_pk_add_f32 v[62:63], v[62:63], 1.0 op_sel_hi:[1,0]
    v_rcp_f32 v48, v48
    v_rcp_f32 v49, v49
    v_rcp_f32 v50, v50
    v_rcp_f32 v51, v51
    v_rcp_f32 v52, v52
    v_rcp_f32 v53, v53
    v_rcp_f32 v54, v54
    v_rcp_f32 v55, v55
    v_rcp_f32 v56, v56
    v_rcp_f32 v57, v57
    v_rcp_f32 v58, v58
    v_rcp_f32 v59, v59
    v_rcp_f32 v60, v60
    v_rcp_f32 v61, v61
    v_rcp_f32 v62, v62
    v_rcp_f32 v63, v63
    s_nop 0
    v_pk_fma_f32 v[108:109], v[32:33], v[48:49], v[108:109]
    v_pk_fma_f32 v[110:111], v[40:41], v[56:57], v[110:111]
    v_pk_fma_f32 v[108:109], v[34:35], v[50:51], v[108:109]
    v_pk_fma_f32 v[110:111], v[42:43], v[58:59], v[110:111]
    v_pk_fma_f32 v[108:109], v[36:37], v[52:53], v[108:109]
    v_pk_fma_f32 v[110:111], v[44:45], v[60:61], v[110:111]
    v_pk_fma_f32 v[108:109], v[38:39], v[54:55], v[108:109]
    v_pk_fma_f32 v[110:111], v[46:47], v[62:63], v[110:111]
    v_mfma_f32_32x32x16_bf16 v[32:47], v[64:67], a[12:15], 0
    v_exp_f32 v48, v16
    v_exp_f32 v49, v17
    v_exp_f32 v56, v24
    v_mfma_f32_32x32x16_bf16 v[32:47], v[68:71], a[28:31], v[32:47]
    v_exp_f32 v57, v25
    v_exp_f32 v50, v18
    v_exp_f32 v51, v19
    v_mfma_f32_32x32x16_bf16 v[32:47], v[72:75], a[44:47], v[32:47]
    v_exp_f32 v58, v26
    v_exp_f32 v59, v27
    v_exp_f32 v52, v20
    v_mfma_f32_32x32x16_bf16 v[32:47], v[76:79], a[60:63], v[32:47]
    v_exp_f32 v53, v21
    v_exp_f32 v60, v28
    v_exp_f32 v61, v29
    v_mfma_f32_32x32x16_bf16 v[32:47], v[80:83], a[76:79], v[32:47]
    v_exp_f32 v54, v22
    v_exp_f32 v55, v23
    v_exp_f32 v62, v30
    v_mfma_f32_32x32x16_bf16 v[32:47], v[84:87], v[100:103], v[32:47]
    v_exp_f32 v63, v31
    s_nop 0
    s_sub_u32 s26, s26, 1
    s_cbranch_scc1 S_last1
    s_waitcnt vmcnt(5) lgkmcnt(0)
    v_and_or_b32 v144, v142, s64, v155
    ds_read_b128 v[64:67], v150 offset:0
    ds_read_b128 v[68:71], v151 offset:0
    ds_read_b128 v[72:75], v152 offset:0
    ds_read_b128 v[76:79], v153 offset:0
    ds_read_b128 v[80:83], v154 offset:0
    ds_read_b128 v[84:87], v144 offset:0
    v_pk_add_f32 v[48:49], v[48:49], 1.0 op_sel_hi:[1,0]
    v_pk_add_f32 v[50:51], v[50:51], 1.0 op_sel_hi:[1,0]
    v_pk_add_f32 v[52:53], v[52:53], 1.0 op_sel_hi:[1,0]
    v_pk_add_f32 v[54:55], v[54:55], 1.0 op_sel_hi:[1,0]
    v_pk_add_f32 v[56:57], v[56:57], 1.0 op_sel_hi:[1,0]
    v_pk_add_f32 v[58:59], v[58:59], 1.0 op_sel_hi:[1,0]
    v_pk_add_f32 v[60:61], v[60:61], 1.0 op_sel_hi:[1,0]
    v_pk_add_f32 v[62:63], v[62:63], 1.0 op_sel_hi:[1,0]
    v_rcp_f32 v48, v48
    v_rcp_f32 v49, v49
    v_rcp_f32 v50, v50
    v_rcp_f32 v51, v51
    v_rcp_f32 v52, v52
    v_rcp_f32 v53, v53
    v_rcp_f32 v54, v54
    v_rcp_f32 v55, v55
    v_rcp_f32 v56, v56
    v_rcp_f32 v57, v57
    v_rcp_f32 v58, v58
    v_rcp_f32 v59, v59
    v_rcp_f32 v60, v60
    v_rcp_f32 v61, v61
    v_rcp_f32 v62, v62
    v_rcp_f32 v63, v63
    s_nop 0
    v_pk_fma_f32 v[112:113], v[16:17], v[48:49], v[112:113]
    v_pk_fma_f32 v[114:115], v[24:25], v[56:57], v[114:115]
    v_pk_fma_f32 v[112:113], v[18:19], v[50:51], v[112:113]
    v_pk_fma_f32 v[114:115], v[26:27], v[58:59], v[114:115]
    v_pk_fma_f32 v[112:113], v[20:21], v[52:53], v[112:113]
    v_pk_fma_f32 v[114:115], v[28:29], v[60:61], v[114:115]
    v_pk_fma_f32 v[112:113], v[22:23], v[54:55], v[112:113]
    v_pk_fma_f32 v[114:115], v[30:31], v[62:63], v[114:115]
    s_waitcnt lgkmcnt(0)
    v_mfma_f32_32x32x16_bf16 v[16:31], v[64:67], a[0:3], 0
    v_exp_f32 v48, v32
    v_exp_f32 v49, v33
    v_exp_f32 v56, v40
    v_mfma_f32_32x32x16_bf16 v[16:31], v[68:71], a[16:19], v[16:31]
    v_exp_f32 v57, v41
    v_exp_f32 v50, v34
    v_exp_f32 v51, v35
    v_mfma_f32_32x32x16_bf16 v[16:31], v[72:75], a[32:35], v[16:31]
    v_exp_f32 v58, v42
    v_exp_f32 v59, v43
    v_exp_f32 v52, v36
    v_mfma_f32_32x32x16_bf16 v[16:31], v[76:79], a[48:51], v[16:31]
    v_exp_f32 v53, v37
    v_exp_f32 v60, v44
    v_exp_f32 v61, v45
    v_mfma_f32_32x32x16_bf16 v[16:31], v[80:83], a[64:67], v[16:31]
    v_exp_f32 v54, v38
    v_exp_f32 v55, v39
    v_exp_f32 v62, v46
    v_mfma_f32_32x32x16_bf16 v[16:31], v[84:87], v[88:91], v[16:31]
    v_exp_f32 v63, v47
    s_nop 0
    v_add_u32 v146, 64, v146
    v_add_u32 v147, 64, v147
    v_add_u32 v148, 64, v148
    v_add_u32 v149, 64, v149
    s_cmp_gt_u32 s26, 1
    s_cselect_b32 s6, 10000, 0
    s_cselect_b32 s10, 640000, 0
    s_add_u32 m0, s27, 4096
    s_nop 0
    buffer_load_dwordx4 v[140:141], s[8:11], 0 idxen offen lds
    s_add_u32 m0, s27, 0
    s_nop 0
    buffer_load_dwordx4 v[132:133], s[4:7], 0 idxen offen offset:0 lds
    buffer_load_dwordx4 v[134:135], s[4:7], 0 idxen offen offset:1024 lds
    buffer_load_dwordx4 v[136:137], s[4:7], 0 idxen offen offset:2048 lds
    buffer_load_dwordx4 v[138:139], s[4:7], 0 idxen offen offset:3072 lds
    v_pk_add_f32 v[48:49], v[48:49], 1.0 op_sel_hi:[1,0]
    v_pk_add_f32 v[50:51], v[50:51], 1.0 op_sel_hi:[1,0]
    v_pk_add_f32 v[52:53], v[52:53], 1.0 op_sel_hi:[1,0]
    v_pk_add_f32 v[54:55], v[54:55], 1.0 op_sel_hi:[1,0]
    v_pk_add_f32 v[56:57], v[56:57], 1.0 op_sel_hi:[1,0]
    v_pk_add_f32 v[58:59], v[58:59], 1.0 op_sel_hi:[1,0]
    v_pk_add_f32 v[60:61], v[60:61], 1.0 op_sel_hi:[1,0]
    v_pk_add_f32 v[62:63], v[62:63], 1.0 op_sel_hi:[1,0]
    v_rcp_f32 v48, v48
    v_rcp_f32 v49, v49
    v_rcp_f32 v50, v50
    v_rcp_f32 v51, v51
    v_rcp_f32 v52, v52
    v_rcp_f32 v53, v53
    v_rcp_f32 v54, v54
    v_rcp_f32 v55, v55
    v_rcp_f32 v56, v56
    v_rcp_f32 v57, v57
    v_rcp_f32 v58, v58
    v_rcp_f32 v59, v59
    v_rcp_f32 v60, v60
    v_rcp_f32 v61, v61
    v_rcp_f32 v62, v62
    v_rcp_f32 v63, v63
    s_nop 0
    v_pk_fma_f32 v[116:117], v[32:33], v[48:49], v[116:117]
    v_pk_fma_f32 v[118:119], v[40:41], v[56:57], v[118:119]
    v_pk_fma_f32 v[116:117], v[34:35], v[50:51], v[116:117]
    v_pk_fma_f32 v[118:119], v[42:43], v[58:59], v[118:119]
    v_pk_fma_f32 v[116:117], v[36:37], v[52:53], v[116:117]
    v_pk_fma_f32 v[118:119], v[44:45], v[60:61], v[118:119]
    v_pk_fma_f32 v[116:117], v[38:39], v[54:55], v[116:117]
    v_pk_fma_f32 v[118:119], v[46:47], v[62:63], v[118:119]
    s_branch S_it0
S_last0:
    s_waitcnt lgkmcnt(0)
    v_mov_b32 v143, v142
S_last1:
    v_pk_add_f32 v[48:49], v[48:49], 1.0 op_sel_hi:[1,0]
    v_pk_add_f32 v[50:51], v[50:51], 1.0 op_sel_hi:[1,0]
    v_pk_add_f32 v[52:53], v[52:53], 1.0 op_sel_hi:[1,0]
    v_pk_add_f32 v[54:55], v[54:55], 1.0 op_sel_hi:[1,0]
    v_pk_add_f32 v[56:57], v[56:57], 1.0 op_sel_hi:[1,0]
    v_pk_add_f32 v[58:59], v[58:59], 1.0 op_sel_hi:[1,0]
    v_pk_add_f32 v[60:61], v[60:61], 1.0 op_sel_hi:[1,0]
    v_pk_add_f32 v[62:63], v[62:63], 1.0 op_sel_hi:[1,0]
    v_rcp_f32 v48, v48
    v_rcp_f32 v49, v49
    v_rcp_f32 v50, v50
    v_rcp_f32 v51, v51
    v_rcp_f32 v52, v52
    v_rcp_f32 v53, v53
    v_rcp_f32 v54, v54
    v_rcp_f32 v55, v55
    v_rcp_f32 v56, v56
    v_rcp_f32 v57, v57
    v_rcp_f32 v58, v58
    v_rcp_f32 v59, v59
    v_rcp_f32 v60, v60
    v_rcp_f32 v61, v61
    v_rcp_f32 v62, v62
    v_rcp_f32 v63, v63
    s_nop 0
    v_pk_fma_f32 v[112:113], v[16:17], v[48:49], v[112:113]
    v_pk_fma_f32 v[114:115], v[24:25], v[56:57], v[114:115]
    v_pk_fma_f32 v[112:113], v[18:19], v[50:51], v[112:113]
    v_pk_fma_f32 v[114:115], v[26:27], v[58:59], v[114:115]
    v_pk_fma_f32 v[112:113], v[20:21], v[52:53], v[112:113]
    v_pk_fma_f32 v[114:115], v[28:29], v[60:61], v[114:115]
    v_pk_fma_f32 v[112:113], v[22:23], v[54:55], v[112:113]
    v_pk_fma_f32 v[114:115], v[30:31], v[62:63], v[114:115]
    v_exp_f32 v48, v32
    v_exp_f32 v49, v33
    v_exp_f32 v56, v40
    v_exp_f32 v57, v41
    v_exp_f32 v50, v34
    v_exp_f32 v51, v35
    v_exp_f32 v58, v42
    v_exp_f32 v59, v43
    v_exp_f32 v52, v36
    v_exp_f32 v53, v37
    v_exp_f32 v60, v44
    v_exp_f32 v61, v45
    v_exp_f32 v54, v38
    v_exp_f32 v55, v39
    v_exp_f32 v62, v46
    v_exp_f32 v63, v47
    s_nop 0
    v_pk_add_f32 v[48:49], v[48:49], 1.0 op_sel_hi:[1,0]
    v_pk_add_f32 v[50:51], v[50:51], 1.0 op_sel_hi:[1,0]
    v_pk_add_f32 v[52:53], v[52:53], 1.0 op_sel_hi:[1,0]
    v_pk_add_f32 v[54:55], v[54:55], 1.0 op_sel_hi:[1,0]
    v_pk_add_f32 v[56:57], v[56:57], 1.0 op_sel_hi:[1,0]
    v_pk_add_f32 v[58:59], v[58:59], 1.0 op_sel_hi:[1,0]
    v_pk_add_f32 v[60:61], v[60:61], 1.0 op_sel_hi:[1,0]
    v_pk_add_f32 v[62:63], v[62:63], 1.0 op_sel_hi:[1,0]
    v_rcp_f32 v48, v48
    v_rcp_f32 v49, v49
    v_rcp_f32 v50, v50
    v_rcp_f32 v51, v51
    v_rcp_f32 v52, v52
    v_rcp_f32 v53, v53
    v_rcp_f32 v54, v54
    v_rcp_f32 v55, v55
    v_rcp_f32 v56, v56
    v_rcp_f32 v57, v57
    v_rcp_f32 v58, v58
    v_rcp_f32 v59, v59
    v_rcp_f32 v60, v60
    v_rcp_f32 v61, v61
    v_rcp_f32 v62, v62
    v_rcp_f32 v63, v63
    s_nop 0
    v_pk_fma_f32 v[116:117], v[32:33], v[48:49], v[116:117]
    v_pk_fma_f32 v[118:119], v[40:41], v[56:57], v[118:119]
    v_pk_fma_f32 v[116:117], v[34:35], v[50:51], v[116:117]
    v_pk_fma_f32 v[118:119], v[42:43], v[58:59], v[118:119]
    v_pk_fma_f32 v[116:117], v[36:37], v[52:53], v[116:117]
    v_pk_fma_f32 v[118:119], v[44:45], v[60:61], v[118:119]
    v_pk_fma_f32 v[116:117], v[38:39], v[54:55], v[116:117]
    v_pk_fma_f32 v[118:119], v[46:47], v[62:63], v[118:119]
S_tail1:
    v_cmp_gt_i16 vcc, 0, v143
    s_cbranch_vccnz S_tlfl
S_tl_nofl:
    v_mul_u32_u24 v158, 66, v155
    s_mul_i32 s30, s24, 10368
    s_add_u32 s30, s30, 51840
    v_add3_u32 v157, v156, v158, s30
    v_add_u32 v158, 2112, v157
    s_waitcnt vmcnt(0)
    ds_write2_b32 v157, v104, v108 offset0:0 offset1:32
    ds_write2_b32 v157, v112, v116 offset0:64 offset1:96
    ds_write2_b32 v157, v105, v109 offset0:132 offset1:164
    ds_write2_b32 v157, v113, v117 offset0:196 offset1:228
    ds_write2_b32 v158, v106, v110 offset0:0 offset1:32
    ds_write2_b32 v158, v114, v118 offset0:64 offset1:96
    ds_write2_b32 v158, v107, v111 offset0:132 offset1:164
    ds_write2_b32 v158, v115, v119 offset0:196 offset1:228
    s_waitcnt lgkmcnt(0)
    s_barrier
    s_cmp_ge_u32 s24, 5
    s_cbranch_scc1 S_rd_done
    s_lshl_b32 s30, s24, 3
    v_lshrrev_b32 v2, 3, v1
    v_add_u32 v2, s30, v2
    v_lshlrev_b32 v3, 2, v2
    ds_bpermute_b32 v4, v3, v15
    v_and_b32 v5, 7, v1
    v_mul_u32_u24 v6, 528, v2
    v_lshl_add_u32 v6, v5, 6, v6
    ds_read_b128 v[80:83], v6 offset:27904
    ds_read_b128 v[84:87], v6 offset:27920
    ds_read_b128 v[88:91], v6 offset:27936
    ds_read_b128 v[92:95], v6 offset:27952
    v_lshlrev_b32 v5, 6, v5
    v_add_u32 v5, 79744, v5
    s_waitcnt lgkmcnt(4)
    v_and_b32 v7, 0xff, v4
    v_lshrrev_b32 v4, 8, v4
S_rd_loop:
    v_cmp_lt_u32 vcc, v7, v4
    s_and_b64 exec, exec, vcc
    s_cbranch_execz S_rd_end
    v_lshrrev_b32 v9, 3, v7
    v_and_b32 v10, 7, v7
    v_mul_u32_u24 v9, 10368, v9
    v_mul_u32_u24 v10, 528, v10
    v_add3_u32 v9, v9, v10, v5
    ds_read_b128 v[96:99], v9 offset:0
    ds_read_b128 v[100:103], v9 offset:16
    ds_read_b128 v[104:107], v9 offset:32
    ds_read_b128 v[108:111], v9 offset:48
    v_add_u32 v7, 1, v7
    s_waitcnt lgkmcnt(0)
    v_pk_add_f32 v[80:81], v[80:81], v[96:97]
    v_pk_add_f32 v[82:83], v[82:83], v[98:99]
    v_pk_add_f32 v[84:85], v[84:85], v[100:101]
    v_pk_add_f32 v[86:87], v[86:87], v[102:103]
    v_pk_add_f32 v[88:89], v[88:89], v[104:105]
    v_pk_add_f32 v[90:91], v[90:91], v[106:107]
    v_pk_add_f32 v[92:93], v[92:93], v[108:109]
    v_pk_add_f32 v[94:95], v[94:95], v[110:111]
    s_branch S_rd_loop
S_rd_end:
    s_mov_b64 exec, -1
    s_waitcnt lgkmcnt(0)
    ds_write_b128 v6, v[80:83] offset:27904
    ds_write_b128 v6, v[84:87] offset:27920
    ds_write_b128 v6, v[88:91] offset:27936
    ds_write_b128 v6, v[92:95] offset:27952
S_rd_done:
    s_waitcnt lgkmcnt(0)
    s_barrier
    s_add_u32 s75, s75, 1
    s_cmp_lt_u32 s75, 3
    s_cbranch_scc1 S_pass
    s_mov_b32 s75, 0
    s_add_u32 s74, s74, 1
    s_cmp_lt_u32 s74, 256
    s_cbranch_scc1 S_pass
    v_mov_b32 v15, 0
    s_sub_u32 s3, s24, 0
    s_and_b32 s3, s3, 3
    s_lshl_b32 s3, s3, 4
    v_and_b32 v4, 15, v1
    v_add_u32 v4, s3, v4
    v_lshlrev_b32 v5, 2, v4
    ds_bpermute_b32 v6, v5, v15
    ds_read_b32 v5, v5 offset:512
    v_lshrrev_b32 v2, 4, v1
    v_lshlrev_b32 v9, 3, v2
    v_and_b32 v8, 1, v2
    v_lshrrev_b32 v2, 1, v2
    v_lshl_or_b32 v2, v8, 1, v2
    v_bfe_u32 v3, v1, 2, 2
    v_lshl_add_u32 v3, v2, 5, v3
    v_lshlrev_b32 v3, 7, v3
    v_and_b32 v7, 3, v1
    v_lshl_add_u32 v3, v7, 3, v3
    v_bfe_u32 v7, v1, 3, 2
    v_lshl_add_u32 v3, v7, 5, v3
    v_add_u32 v3, 63360, v3
    v_lshlrev_b32 v2, 7, v2
    v_mul_u32_u24 v8, 528, v4
    v_add_u32 v8, 27904, v8
    v_lshl_add_u32 v4, v4, 8, s73
    v_lshl_add_u32 v4, v4, 7, v9
    v_mov_b32 v11, 2048
    s_waitcnt lgkmcnt(0)
    v_cmp_ne_u32 vcc, 0, v5
    v_lshrrev_b32 v7, 8, v6
    v_and_b32 v6, 0xff, v6
    v_cndmask_b32 v8, v11, v8, vcc
    v_add_u32 v8, v8, v2
    v_lshrrev_b32 v5, 3, v5
    v_cvt_f32_u32 v12, v5
    v_lshrrev_b32 v157, 3, v6
    v_and_b32 v158, 7, v6
    v_cmp_lt_u32 vcc, v6, v7
    v_mov_b32 v159, 2048
    v_mul_u32_u24 v157, 10368, v157
    v_mul_u32_u24 v158, 528, v158
    v_add_u32 v157, 79744, v157
    v_add_u32 v157, v157, v158
    v_cndmask_b32 v157, v159, v157, vcc
    v_add_u32 v9, v157, v2
    v_add_u32 v6, 1, v6
    v_lshrrev_b32 v157, 3, v6
    v_and_b32 v158, 7, v6
    v_cmp_lt_u32 vcc, v6, v7
    v_mov_b32 v159, 2048
    v_mul_u32_u24 v157, 10368, v157
    v_mul_u32_u24 v158, 528, v158
    v_add_u32 v157, 79744, v157
    v_add_u32 v157, v157, v158
    v_cndmask_b32 v157, v159, v157, vcc
    v_add_u32 v10, v157, v2
    v_add_u32 v6, 1, v6
    v_lshrrev_b32 v157, 3, v6
    v_and_b32 v158, 7, v6
    v_cmp_lt_u32 vcc, v6, v7
    v_mov_b32 v159, 2048
    v_mul_u32_u24 v157, 10368, v157
    v_mul_u32_u24 v158, 528, v158
    v_add_u32 v157, 79744, v157
    v_add_u32 v157, v157, v158
    v_cndmask_b32 v157, v159, v157, vcc
    v_add_u32 v11, v157, v2
    v_add_u32 v6, 1, v6
    s_sub_u32 s3, s24, 0
    s_cmp_ge_u32 s3, 3
    s_cbranch_scc1 S_now2
    ds_read_b64_tr_b16 a[0:1], v3 offset:0
    ds_read_b64_tr_b16 a[2:3], v3 offset:512
    ds_read_b64_tr_b16 a[4:5], v3 offset:1024
    ds_read_b64_tr_b16 a[6:7], v3 offset:1536
    ds_read_b64_tr_b16 a[8:9], v3 offset:2048
    ds_read_b64_tr_b16 a[10:11], v3 offset:2560
    ds_read_b64_tr_b16 a[12:13], v3 offset:3072
    ds_read_b64_tr_b16 a[14:15], v3 offset:3584
    v_xor_b32 v157, 32, v3
    ds_read_b64_tr_b16 a[16:17], v157 offset:0
    ds_read_b64_tr_b16 a[18:19], v157 offset:512
    ds_read_b64_tr_b16 a[20:21], v157 offset:1024
    ds_read_b64_tr_b16 a[22:23], v157 offset:1536
    ds_read_b64_tr_b16 a[24:25], v157 offset:2048
    ds_read_b64_tr_b16 a[26:27], v157 offset:2560
    ds_read_b64_tr_b16 a[28:29], v157 offset:3072
    ds_read_b64_tr_b16 a[30:31], v157 offset:3584
    v_xor_b32 v157, 64, v3
    ds_read_b64_tr_b16 a[32:33], v157 offset:0
    ds_read_b64_tr_b16 a[34:35], v157 offset:512
    ds_read_b64_tr_b16 a[36:37], v157 offset:1024
    ds_read_b64_tr_b16 a[38:39], v157 offset:1536
    ds_read_b64_tr_b16 a[40:41], v157 offset:2048
    ds_read_b64_tr_b16 a[42:43], v157 offset:2560
    ds_read_b64_tr_b16 a[44:45], v157 offset:3072
    ds_read_b64_tr_b16 a[46:47], v157 offset:3584
    v_xor_b32 v157, 96, v3
    ds_read_b64_tr_b16 a[48:49], v157 offset:0
    ds_read_b64_tr_b16 a[50:51], v157 offset:512
    ds_read_b64_tr_b16 a[52:53], v157 offset:1024
    ds_read_b64_tr_b16 a[54:55], v157 offset:1536
    ds_read_b64_tr_b16 a[56:57], v157 offset:2048
    ds_read_b64_tr_b16 a[58:59], v157 offset:2560
    ds_read_b64_tr_b16 a[60:61], v157 offset:3072
    ds_read_b64_tr_b16 a[62:63], v157 offset:3584
S_now2:
    v_mov_b32 v5, 0
    s_waitcnt lgkmcnt(0)
    s_branch K_FINAL
S_fl0:
    s_bitcmp1_b32 vcc_lo, 2
    s_cbranch_scc0 S_fl0_go
    s_cmp_gt_u32 s25, 2
    s_cselect_b32 s6, 10000, 0
    s_cselect_b32 s10, 640000, 0
    s_waitcnt lgkmcnt(0)
    s_add_u32 m0, s27, 4096
    s_nop 0
    buffer_load_dwordx4 v[140:141], s[8:11], 0 idxen offen lds
    s_add_u32 m0, s27, 0
    s_nop 0
    buffer_load_dwordx4 v[132:133], s[4:7], 0 idxen offen offset:0 lds
    buffer_load_dwordx4 v[134:135], s[4:7], 0 idxen offen offset:1024 lds
    buffer_load_dwordx4 v[136:137], s[4:7], 0 idxen offen offset:2048 lds
    buffer_load_dwordx4 v[138:139], s[4:7], 0 idxen offen offset:3072 lds
    s_branch S_flr0
S_fl0_go:
    s_and_b32 s30, vcc_lo, 0x33
    s_cbranch_scc0 S_fl0_u1
    s_and_b32 s30, vcc_lo, 0x3
    s_cbranch_scc0 S_fl0_0h1
    s_bitcmp1_b32 vcc_lo, 0
    s_cbranch_scc0 S_fl0_00p1
    v_readlane_b32 s30, v143, 0
    s_mov_b64 exec, s[66:67]
    s_bfe_u32 s30, s30, 0x60005
    s_mul_i32 s30, s30, 528
    v_add_u32 v157, s30, v156
    ds_read_b32 v120, v157 offset:0
    ds_read_b32 v121, v157 offset:128
    ds_read_b32 v122, v157 offset:256
    ds_read_b32 v123, v157 offset:384
    s_waitcnt lgkmcnt(0)
    v_add_f32 v120, v120, v104
    v_add_f32 v121, v121, v108
    v_add_f32 v122, v122, v112
    v_add_f32 v123, v123, v116
    ds_write_b32 v157, v120 offset:0
    ds_write_b32 v157, v121 offset:128
    ds_write_b32 v157, v122 offset:256
    ds_write_b32 v157, v123 offset:384
    v_mov_b32 v104, 0
    v_mov_b32 v108, 0
    v_mov_b32 v112, 0
    v_mov_b32 v116, 0
    s_mov_b64 exec, -1
    s_and_b32 vcc_lo, vcc_lo, 0x330032
    s_cbranch_scc0 S_flr0
    s_branch S_fl0_go
S_fl0_00p1:
    v_readlane_b32 s30, v143, 1
    s_mov_b64 exec, s[66:67]
    s_bfe_u32 s30, s30, 0x60005
    s_mul_i32 s30, s30, 528
    v_add_u32 v157, s30, v156
    ds_read_b32 v120, v157 offset:0
    ds_read_b32 v121, v157 offset:128
    ds_read_b32 v122, v157 offset:256
    ds_read_b32 v123, v157 offset:384
    s_waitcnt lgkmcnt(0)
    v_add_f32 v120, v120, v105
    v_add_f32 v121, v121, v109
    v_add_f32 v122, v122, v113
    v_add_f32 v123, v123, v117
    ds_write_b32 v157, v120 offset:0
    ds_write_b32 v157, v121 offset:128
    ds_write_b32 v157, v122 offset:256
    ds_write_b32 v157, v123 offset:384
    v_mov_b32 v105, 0
    v_mov_b32 v109, 0
    v_mov_b32 v113, 0
    v_mov_b32 v117, 0
    s_mov_b64 exec, -1
    s_and_b32 vcc_lo, vcc_lo, 0x330031
    s_cbranch_scc0 S_flr0
    s_branch S_fl0_go
S_fl0_0h1:
    s_bitcmp1_b32 vcc_lo, 4
    s_cbranch_scc0 S_fl0_01p1
    v_readlane_b32 s30, v143, 4
    s_mov_b64 exec, s[68:69]
    s_bfe_u32 s30, s30, 0x60005
    s_mul_i32 s30, s30, 528
    v_add_u32 v157, s30, v156
    ds_read_b32 v120, v157 offset:0
    ds_read_b32 v121, v157 offset:128
    ds_read_b32 v122, v157 offset:256
    ds_read_b32 v123, v157 offset:384
    s_waitcnt lgkmcnt(0)
    v_add_f32 v120, v120, v104
    v_add_f32 v121, v121, v108
    v_add_f32 v122, v122, v112
    v_add_f32 v123, v123, v116
    ds_write_b32 v157, v120 offset:0
    ds_write_b32 v157, v121 offset:128
    ds_write_b32 v157, v122 offset:256
    ds_write_b32 v157, v123 offset:384
    v_mov_b32 v104, 0
    v_mov_b32 v108, 0
    v_mov_b32 v112, 0
    v_mov_b32 v116, 0
    s_mov_b64 exec, -1
    s_and_b32 vcc_lo, vcc_lo, 0x330023
    s_cbranch_scc0 S_flr0
    s_branch S_fl0_go
S_fl0_01p1:
    v_readlane_b32 s30, v143, 5
    s_mov_b64 exec, s[68:69]
    s_bfe_u32 s30, s30, 0x60005
    s_mul_i32 s30, s30, 528
    v_add_u32 v157, s30, v156
    ds_read_b32 v120, v157 offset:0
    ds_read_b32 v121, v157 offset:128
    ds_read_b32 v122, v157 offset:256
    ds_read_b32 v123, v157 offset:384
    s_waitcnt lgkmcnt(0)
    v_add_f32 v120, v120, v105
    v_add_f32 v121, v121, v109
    v_add_f32 v122, v122, v113
    v_add_f32 v123, v123, v117
    ds_write_b32 v157, v120 offset:0
    ds_write_b32 v157, v121 offset:128
    ds_write_b32 v157, v122 offset:256
    ds_write_b32 v157, v123 offset:384
    v_mov_b32 v105, 0
    v_mov_b32 v109, 0
    v_mov_b32 v113, 0
    v_mov_b32 v117, 0
    s_mov_b64 exec, -1
    s_and_b32 vcc_lo, vcc_lo, 0x330013
    s_cbranch_scc0 S_flr0
    s_branch S_fl0_go
S_fl0_u1:
    s_and_b32 s30, vcc_lo, 0x330000
    s_cbranch_scc0 S_flr0
    s_and_b32 s30, vcc_lo, 0x30000
    s_cbranch_scc0 S_fl0_1h1
    s_bitcmp1_b32 vcc_lo, 16
    s_cbranch_scc0 S_fl0_10p1
    v_readlane_b32 s30, v143, 16
    s_mov_b64 exec, s[66:67]
    s_bfe_u32 s30, s30, 0x60005
    s_mul_i32 s30, s30, 528
    v_add_u32 v157, s30, v156
    ds_read_b32 v120, v157 offset:0
    ds_read_b32 v121, v157 offset:128
    ds_read_b32 v122, v157 offset:256
    ds_read_b32 v123, v157 offset:384
    s_waitcnt lgkmcnt(0)
    v_add_f32 v120, v120, v106
    v_add_f32 v121, v121, v110
    v_add_f32 v122, v122, v114
    v_add_f32 v123, v123, v118
    ds_write_b32 v157, v120 offset:0
    ds_write_b32 v157, v121 offset:128
    ds_write_b32 v157, v122 offset:256
    ds_write_b32 v157, v123 offset:384
    v_mov_b32 v106, 0
    v_mov_b32 v110, 0
    v_mov_b32 v114, 0
    v_mov_b32 v118, 0
    s_mov_b64 exec, -1
    s_and_b32 vcc_lo, vcc_lo, 0x320033
    s_cbranch_scc0 S_flr0
    s_branch S_fl0_go
S_fl0_10p1:
    v_readlane_b32 s30, v143, 17
    s_mov_b64 exec, s[66:67]
    s_bfe_u32 s30, s30, 0x60005
    s_mul_i32 s30, s30, 528
    v_add_u32 v157, s30, v156
    ds_read_b32 v120, v157 offset:0
    ds_read_b32 v121, v157 offset:128
    ds_read_b32 v122, v157 offset:256
    ds_read_b32 v123, v157 offset:384
    s_waitcnt lgkmcnt(0)
    v_add_f32 v120, v120, v107
    v_add_f32 v121, v121, v111
    v_add_f32 v122, v122, v115
    v_add_f32 v123, v123, v119
    ds_write_b32 v157, v120 offset:0
    ds_write_b32 v157, v121 offset:128
    ds_write_b32 v157, v122 offset:256
    ds_write_b32 v157, v123 offset:384
    v_mov_b32 v107, 0
    v_mov_b32 v111, 0
    v_mov_b32 v115, 0
    v_mov_b32 v119, 0
    s_mov_b64 exec, -1
    s_and_b32 vcc_lo, vcc_lo, 0x310033
    s_cbranch_scc0 S_flr0
    s_branch S_fl0_go
S_fl0_1h1:
    s_bitcmp1_b32 vcc_lo, 20
    s_cbranch_scc0 S_fl0_11p1
    v_readlane_b32 s30, v143, 20
    s_mov_b64 exec, s[68:69]
    s_bfe_u32 s30, s30, 0x60005
    s_mul_i32 s30, s30, 528
    v_add_u32 v157, s30, v156
    ds_read_b32 v120, v157 offset:0
    ds_read_b32 v121, v157 offset:128
    ds_read_b32 v122, v157 offset:256
    ds_read_b32 v123, v157 offset:384
    s_waitcnt lgkmcnt(0)
    v_add_f32 v120, v120, v106
    v_add_f32 v121, v121, v110
    v_add_f32 v122, v122, v114
    v_add_f32 v123, v123, v118
    ds_write_b32 v157, v120 offset:0
    ds_write_b32 v157, v121 offset:128
    ds_write_b32 v157, v122 offset:256
    ds_write_b32 v157, v123 offset:384
    v_mov_b32 v106, 0
    v_mov_b32 v110, 0
    v_mov_b32 v114, 0
    v_mov_b32 v118, 0
    s_mov_b64 exec, -1
    s_and_b32 vcc_lo, vcc_lo, 0x230033
    s_cbranch_scc0 S_flr0
    s_branch S_fl0_go
S_fl0_11p1:
    v_readlane_b32 s30, v143, 21
    s_mov_b64 exec, s[68:69]
    s_bfe_u32 s30, s30, 0x60005
    s_mul_i32 s30, s30, 528
    v_add_u32 v157, s30, v156
    ds_read_b32 v120, v157 offset:0
    ds_read_b32 v121, v157 offset:128
    ds_read_b32 v122, v157 offset:256
    ds_read_b32 v123, v157 offset:384
    s_waitcnt lgkmcnt(0)
    v_add_f32 v120, v120, v107
    v_add_f32 v121, v121, v111
    v_add_f32 v122, v122, v115
    v_add_f32 v123, v123, v119
    ds_write_b32 v157, v120 offset:0
    ds_write_b32 v157, v121 offset:128
    ds_write_b32 v157, v122 offset:256
    ds_write_b32 v157, v123 offset:384
    v_mov_b32 v107, 0
    v_mov_b32 v111, 0
    v_mov_b32 v115, 0
    v_mov_b32 v119, 0
    s_mov_b64 exec, -1
    s_and_b32 vcc_lo, vcc_lo, 0x130033
    s_cbranch_scc0 S_flr0
    s_branch S_fl0_go
S_fl1:
S_fl1_go:
    s_and_b32 s30, vcc_lo, 0x33
    s_cbranch_scc0 S_fl1_u1
    s_and_b32 s30, vcc_lo, 0x3
    s_cbranch_scc0 S_fl1_0h1
    s_bitcmp1_b32 vcc_lo, 0
    s_cbranch_scc0 S_fl1_00p1
    v_readlane_b32 s30, v142, 0
    s_mov_b64 exec, s[66:67]
    s_bfe_u32 s30, s30, 0x60005
    s_mul_i32 s30, s30, 528
    v_add_u32 v157, s30, v156
    ds_read_b32 v120, v157 offset:0
    ds_read_b32 v121, v157 offset:128
    ds_read_b32 v122, v157 offset:256
    ds_read_b32 v123, v157 offset:384
    s_waitcnt lgkmcnt(0)
    v_add_f32 v120, v120, v104
    v_add_f32 v121, v121, v108
    v_add_f32 v122, v122, v112
    v_add_f32 v123, v123, v116
    ds_write_b32 v157, v120 offset:0
    ds_write_b32 v157, v121 offset:128
    ds_write_b32 v157, v122 offset:256
    ds_write_b32 v157, v123 offset:384
    v_mov_b32 v104, 0
    v_mov_b32 v108, 0
    v_mov_b32 v112, 0
    v_mov_b32 v116, 0
    s_mov_b64 exec, -1
    s_and_b32 vcc_lo, vcc_lo, 0x330032
    s_cbranch_scc0 S_flr1
    s_branch S_fl1_go
S_fl1_00p1:
    v_readlane_b32 s30, v142, 1
    s_mov_b64 exec, s[66:67]
    s_bfe_u32 s30, s30, 0x60005
    s_mul_i32 s30, s30, 528
    v_add_u32 v157, s30, v156
    ds_read_b32 v120, v157 offset:0
    ds_read_b32 v121, v157 offset:128
    ds_read_b32 v122, v157 offset:256
    ds_read_b32 v123, v157 offset:384
    s_waitcnt lgkmcnt(0)
    v_add_f32 v120, v120, v105
    v_add_f32 v121, v121, v109
    v_add_f32 v122, v122, v113
    v_add_f32 v123, v123, v117
    ds_write_b32 v157, v120 offset:0
    ds_write_b32 v157, v121 offset:128
    ds_write_b32 v157, v122 offset:256
    ds_write_b32 v157, v123 offset:384
    v_mov_b32 v105, 0
    v_mov_b32 v109, 0
    v_mov_b32 v113, 0
    v_mov_b32 v117, 0
    s_mov_b64 exec, -1
    s_and_b32 vcc_lo, vcc_lo, 0x330031
    s_cbranch_scc0 S_flr1
    s_branch S_fl1_go
S_fl1_0h1:
    s_bitcmp1_b32 vcc_lo, 4
    s_cbranch_scc0 S_fl1_01p1
    v_readlane_b32 s30, v142, 4
    s_mov_b64 exec, s[68:69]
    s_bfe_u32 s30, s30, 0x60005
    s_mul_i32 s30, s30, 528
    v_add_u32 v157, s30, v156
    ds_read_b32 v120, v157 offset:0
    ds_read_b32 v121, v157 offset:128
    ds_read_b32 v122, v157 offset:256
    ds_read_b32 v123, v157 offset:384
    s_waitcnt lgkmcnt(0)
    v_add_f32 v120, v120, v104
    v_add_f32 v121, v121, v108
    v_add_f32 v122, v122, v112
    v_add_f32 v123, v123, v116
    ds_write_b32 v157, v120 offset:0
    ds_write_b32 v157, v121 offset:128
    ds_write_b32 v157, v122 offset:256
    ds_write_b32 v157, v123 offset:384
    v_mov_b32 v104, 0
    v_mov_b32 v108, 0
    v_mov_b32 v112, 0
    v_mov_b32 v116, 0
    s_mov_b64 exec, -1
    s_and_b32 vcc_lo, vcc_lo, 0x330023
    s_cbranch_scc0 S_flr1
    s_branch S_fl1_go
S_fl1_01p1:
    v_readlane_b32 s30, v142, 5
    s_mov_b64 exec, s[68:69]
    s_bfe_u32 s30, s30, 0x60005
    s_mul_i32 s30, s30, 528
    v_add_u32 v157, s30, v156
    ds_read_b32 v120, v157 offset:0
    ds_read_b32 v121, v157 offset:128
    ds_read_b32 v122, v157 offset:256
    ds_read_b32 v123, v157 offset:384
    s_waitcnt lgkmcnt(0)
    v_add_f32 v120, v120, v105
    v_add_f32 v121, v121, v109
    v_add_f32 v122, v122, v113
    v_add_f32 v123, v123, v117
    ds_write_b32 v157, v120 offset:0
    ds_write_b32 v157, v121 offset:128
    ds_write_b32 v157, v122 offset:256
    ds_write_b32 v157, v123 offset:384
    v_mov_b32 v105, 0
    v_mov_b32 v109, 0
    v_mov_b32 v113, 0
    v_mov_b32 v117, 0
    s_mov_b64 exec, -1
    s_and_b32 vcc_lo, vcc_lo, 0x330013
    s_cbranch_scc0 S_flr1
    s_branch S_fl1_go
S_fl1_u1:
    s_and_b32 s30, vcc_lo, 0x330000
    s_cbranch_scc0 S_flr1
    s_and_b32 s30, vcc_lo, 0x30000
    s_cbranch_scc0 S_fl1_1h1
    s_bitcmp1_b32 vcc_lo, 16
    s_cbranch_scc0 S_fl1_10p1
    v_readlane_b32 s30, v142, 16
    s_mov_b64 exec, s[66:67]
    s_bfe_u32 s30, s30, 0x60005
    s_mul_i32 s30, s30, 528
    v_add_u32 v157, s30, v156
    ds_read_b32 v120, v157 offset:0
    ds_read_b32 v121, v157 offset:128
    ds_read_b32 v122, v157 offset:256
    ds_read_b32 v123, v157 offset:384
    s_waitcnt lgkmcnt(0)
    v_add_f32 v120, v120, v106
    v_add_f32 v121, v121, v110
    v_add_f32 v122, v122, v114
    v_add_f32 v123, v123, v118
    ds_write_b32 v157, v120 offset:0
    ds_write_b32 v157, v121 offset:128
    ds_write_b32 v157, v122 offset:256
    ds_write_b32 v157, v123 offset:384
    v_mov_b32 v106, 0
    v_mov_b32 v110, 0
    v_mov_b32 v114, 0
    v_mov_b32 v118, 0
    s_mov_b64 exec, -1
    s_and_b32 vcc_lo, vcc_lo, 0x320033
    s_cbranch_scc0 S_flr1
    s_branch S_fl1_go
S_fl1_10p1:
    v_readlane_b32 s30, v142, 17
    s_mov_b64 exec, s[66:67]
    s_bfe_u32 s30, s30, 0x60005
    s_mul_i32 s30, s30, 528
    v_add_u32 v157, s30, v156
    ds_read_b32 v120, v157 offset:0
    ds_read_b32 v121, v157 offset:128
    ds_read_b32 v122, v157 offset:256
    ds_read_b32 v123, v157 offset:384
    s_waitcnt lgkmcnt(0)
    v_add_f32 v120, v120, v107
    v_add_f32 v121, v121, v111
    v_add_f32 v122, v122, v115
    v_add_f32 v123, v123, v119
    ds_write_b32 v157, v120 offset:0
    ds_write_b32 v157, v121 offset:128
    ds_write_b32 v157, v122 offset:256
    ds_write_b32 v157, v123 offset:384
    v_mov_b32 v107, 0
    v_mov_b32 v111, 0
    v_mov_b32 v115, 0
    v_mov_b32 v119, 0
    s_mov_b64 exec, -1
    s_and_b32 vcc_lo, vcc_lo, 0x310033
    s_cbranch_scc0 S_flr1
    s_branch S_fl1_go
S_fl1_1h1:
    s_bitcmp1_b32 vcc_lo, 20
    s_cbranch_scc0 S_fl1_11p1
    v_readlane_b32 s30, v142, 20
    s_mov_b64 exec, s[68:69]
    s_bfe_u32 s30, s30, 0x60005
    s_mul_i32 s30, s30, 528
    v_add_u32 v157, s30, v156
    ds_read_b32 v120, v157 offset:0
    ds_read_b32 v121, v157 offset:128
    ds_read_b32 v122, v157 offset:256
    ds_read_b32 v123, v157 offset:384
    s_waitcnt lgkmcnt(0)
    v_add_f32 v120, v120, v106
    v_add_f32 v121, v121, v110
    v_add_f32 v122, v122, v114
    v_add_f32 v123, v123, v118
    ds_write_b32 v157, v120 offset:0
    ds_write_b32 v157, v121 offset:128
    ds_write_b32 v157, v122 offset:256
    ds_write_b32 v157, v123 offset:384
    v_mov_b32 v106, 0
    v_mov_b32 v110, 0
    v_mov_b32 v114, 0
    v_mov_b32 v118, 0
    s_mov_b64 exec, -1
    s_and_b32 vcc_lo, vcc_lo, 0x230033
    s_cbranch_scc0 S_flr1
    s_branch S_fl1_go
S_fl1_11p1:
    v_readlane_b32 s30, v142, 21
    s_mov_b64 exec, s[68:69]
    s_bfe_u32 s30, s30, 0x60005
    s_mul_i32 s30, s30, 528
    v_add_u32 v157, s30, v156
    ds_read_b32 v120, v157 offset:0
    ds_read_b32 v121, v157 offset:128
    ds_read_b32 v122, v157 offset:256
    ds_read_b32 v123, v157 offset:384
    s_waitcnt lgkmcnt(0)
    v_add_f32 v120, v120, v107
    v_add_f32 v121, v121, v111
    v_add_f32 v122, v122, v115
    v_add_f32 v123, v123, v119
    ds_write_b32 v157, v120 offset:0
    ds_write_b32 v157, v121 offset:128
    ds_write_b32 v157, v122 offset:256
    ds_write_b32 v157, v123 offset:384
    v_mov_b32 v107, 0
    v_mov_b32 v111, 0
    v_mov_b32 v115, 0
    v_mov_b32 v119, 0
    s_mov_b64 exec, -1
    s_and_b32 vcc_lo, vcc_lo, 0x130033
    s_cbranch_scc0 S_flr1
    s_branch S_fl1_go
S_tlfl:
S_tlfl_go:
    s_and_b32 s30, vcc_lo, 0x33
    s_cbranch_scc0 S_tlfl_u1
    s_and_b32 s30, vcc_lo, 0x3
    s_cbranch_scc0 S_tlfl_0h1
    s_bitcmp1_b32 vcc_lo, 0
    s_cbranch_scc0 S_tlfl_00p1
    v_readlane_b32 s30, v143, 0
    s_mov_b64 exec, s[66:67]
    s_bfe_u32 s30, s30, 0x60005
    s_mul_i32 s30, s30, 528
    v_add_u32 v157, s30, v156
    ds_read_b32 v120, v157 offset:0
    ds_read_b32 v121, v157 offset:128
    ds_read_b32 v122, v157 offset:256
    ds_read_b32 v123, v157 offset:384
    s_waitcnt lgkmcnt(0)
    v_add_f32 v120, v120, v104
    v_add_f32 v121, v121, v108
    v_add_f32 v122, v122, v112
    v_add_f32 v123, v123, v116
    ds_write_b32 v157, v120 offset:0
    ds_write_b32 v157, v121 offset:128
    ds_write_b32 v157, v122 offset:256
    ds_write_b32 v157, v123 offset:384
    v_mov_b32 v104, 0
    v_mov_b32 v108, 0
    v_mov_b32 v112, 0
    v_mov_b32 v116, 0
    s_mov_b64 exec, -1
    s_and_b32 vcc_lo, vcc_lo, 0x330032
    s_cbranch_scc0 S_tl_nofl
    s_branch S_tlfl_go
S_tlfl_00p1:
    v_readlane_b32 s30, v143, 1
    s_mov_b64 exec, s[66:67]
    s_bfe_u32 s30, s30, 0x60005
    s_mul_i32 s30, s30, 528
    v_add_u32 v157, s30, v156
    ds_read_b32 v120, v157 offset:0
    ds_read_b32 v121, v157 offset:128
    ds_read_b32 v122, v157 offset:256
    ds_read_b32 v123, v157 offset:384
    s_waitcnt lgkmcnt(0)
    v_add_f32 v120, v120, v105
    v_add_f32 v121, v121, v109
    v_add_f32 v122, v122, v113
    v_add_f32 v123, v123, v117
    ds_write_b32 v157, v120 offset:0
    ds_write_b32 v157, v121 offset:128
    ds_write_b32 v157, v122 offset:256
    ds_write_b32 v157, v123 offset:384
    v_mov_b32 v105, 0
    v_mov_b32 v109, 0
    v_mov_b32 v113, 0
    v_mov_b32 v117, 0
    s_mov_b64 exec, -1
    s_and_b32 vcc_lo, vcc_lo, 0x330031
    s_cbranch_scc0 S_tl_nofl
    s_branch S_tlfl_go
S_tlfl_0h1:
    s_bitcmp1_b32 vcc_lo, 4
    s_cbranch_scc0 S_tlfl_01p1
    v_readlane_b32 s30, v143, 4
    s_mov_b64 exec, s[68:69]
    s_bfe_u32 s30, s30, 0x60005
    s_mul_i32 s30, s30, 528
    v_add_u32 v157, s30, v156
    ds_read_b32 v120, v157 offset:0
    ds_read_b32 v121, v157 offset:128
    ds_read_b32 v122, v157 offset:256
    ds_read_b32 v123, v157 offset:384
    s_waitcnt lgkmcnt(0)
    v_add_f32 v120, v120, v104
    v_add_f32 v121, v121, v108
    v_add_f32 v122, v122, v112
    v_add_f32 v123, v123, v116
    ds_write_b32 v157, v120 offset:0
    ds_write_b32 v157, v121 offset:128
    ds_write_b32 v157, v122 offset:256
    ds_write_b32 v157, v123 offset:384
    v_mov_b32 v104, 0
    v_mov_b32 v108, 0
    v_mov_b32 v112, 0
    v_mov_b32 v116, 0
    s_mov_b64 exec, -1
    s_and_b32 vcc_lo, vcc_lo, 0x330023
    s_cbranch_scc0 S_tl_nofl
    s_branch S_tlfl_go
S_tlfl_01p1:
    v_readlane_b32 s30, v143, 5
    s_mov_b64 exec, s[68:69]
    s_bfe_u32 s30, s30, 0x60005
    s_mul_i32 s30, s30, 528
    v_add_u32 v157, s30, v156
    ds_read_b32 v120, v157 offset:0
    ds_read_b32 v121, v157 offset:128
    ds_read_b32 v122, v157 offset:256
    ds_read_b32 v123, v157 offset:384
    s_waitcnt lgkmcnt(0)
    v_add_f32 v120, v120, v105
    v_add_f32 v121, v121, v109
    v_add_f32 v122, v122, v113
    v_add_f32 v123, v123, v117
    ds_write_b32 v157, v120 offset:0
    ds_write_b32 v157, v121 offset:128
    ds_write_b32 v157, v122 offset:256
    ds_write_b32 v157, v123 offset:384
    v_mov_b32 v105, 0
    v_mov_b32 v109, 0
    v_mov_b32 v113, 0
    v_mov_b32 v117, 0
    s_mov_b64 exec, -1
    s_and_b32 vcc_lo, vcc_lo, 0x330013
    s_cbranch_scc0 S_tl_nofl
    s_branch S_tlfl_go
S_tlfl_u1:
    s_and_b32 s30, vcc_lo, 0x330000
    s_cbranch_scc0 S_tl_nofl
    s_and_b32 s30, vcc_lo, 0x30000
    s_cbranch_scc0 S_tlfl_1h1
    s_bitcmp1_b32 vcc_lo, 16
    s_cbranch_scc0 S_tlfl_10p1
    v_readlane_b32 s30, v143, 16
    s_mov_b64 exec, s[66:67]
    s_bfe_u32 s30, s30, 0x60005
    s_mul_i32 s30, s30, 528
    v_add_u32 v157, s30, v156
    ds_read_b32 v120, v157 offset:0
    ds_read_b32 v121, v157 offset:128
    ds_read_b32 v122, v157 offset:256
    ds_read_b32 v123, v157 offset:384
    s_waitcnt lgkmcnt(0)
    v_add_f32 v120, v120, v106
    v_add_f32 v121, v121, v110
    v_add_f32 v122, v122, v114
    v_add_f32 v123, v123, v118
    ds_write_b32 v157, v120 offset:0
    ds_write_b32 v157, v121 offset:128
    ds_write_b32 v157, v122 offset:256
    ds_write_b32 v157, v123 offset:384
    v_mov_b32 v106, 0
    v_mov_b32 v110, 0
    v_mov_b32 v114, 0
    v_mov_b32 v118, 0
    s_mov_b64 exec, -1
    s_and_b32 vcc_lo, vcc_lo, 0x320033
    s_cbranch_scc0 S_tl_nofl
    s_branch S_tlfl_go
S_tlfl_10p1:
    v_readlane_b32 s30, v143, 17
    s_mov_b64 exec, s[66:67]
    s_bfe_u32 s30, s30, 0x60005
    s_mul_i32 s30, s30, 528
    v_add_u32 v157, s30, v156
    ds_read_b32 v120, v157 offset:0
    ds_read_b32 v121, v157 offset:128
    ds_read_b32 v122, v157 offset:256
    ds_read_b32 v123, v157 offset:384
    s_waitcnt lgkmcnt(0)
    v_add_f32 v120, v120, v107
    v_add_f32 v121, v121, v111
    v_add_f32 v122, v122, v115
    v_add_f32 v123, v123, v119
    ds_write_b32 v157, v120 offset:0
    ds_write_b32 v157, v121 offset:128
    ds_write_b32 v157, v122 offset:256
    ds_write_b32 v157, v123 offset:384
    v_mov_b32 v107, 0
    v_mov_b32 v111, 0
    v_mov_b32 v115, 0
    v_mov_b32 v119, 0
    s_mov_b64 exec, -1
    s_and_b32 vcc_lo, vcc_lo, 0x310033
    s_cbranch_scc0 S_tl_nofl
    s_branch S_tlfl_go
S_tlfl_1h1:
    s_bitcmp1_b32 vcc_lo, 20
    s_cbranch_scc0 S_tlfl_11p1
    v_readlane_b32 s30, v143, 20
    s_mov_b64 exec, s[68:69]
    s_bfe_u32 s30, s30, 0x60005
    s_mul_i32 s30, s30, 528
    v_add_u32 v157, s30, v156
    ds_read_b32 v120, v157 offset:0
    ds_read_b32 v121, v157 offset:128
    ds_read_b32 v122, v157 offset:256
    ds_read_b32 v123, v157 offset:384
    s_waitcnt lgkmcnt(0)
    v_add_f32 v120, v120, v106
    v_add_f32 v121, v121, v110
    v_add_f32 v122, v122, v114
    v_add_f32 v123, v123, v118
    ds_write_b32 v157, v120 offset:0
    ds_write_b32 v157, v121 offset:128
    ds_write_b32 v157, v122 offset:256
    ds_write_b32 v157, v123 offset:384
    v_mov_b32 v106, 0
    v_mov_b32 v110, 0
    v_mov_b32 v114, 0
    v_mov_b32 v118, 0
    s_mov_b64 exec, -1
    s_and_b32 vcc_lo, vcc_lo, 0x230033
    s_cbranch_scc0 S_tl_nofl
    s_branch S_tlfl_go
S_tlfl_11p1:
    v_readlane_b32 s30, v143, 21
    s_mov_b64 exec, s[68:69]
    s_bfe_u32 s30, s30, 0x60005
    s_mul_i32 s30, s30, 528
    v_add_u32 v157, s30, v156
    ds_read_b32 v120, v157 offset:0
    ds_read_b32 v121, v157 offset:128
    ds_read_b32 v122, v157 offset:256
    ds_read_b32 v123, v157 offset:384
    s_waitcnt lgkmcnt(0)
    v_add_f32 v120, v120, v107
    v_add_f32 v121, v121, v111
    v_add_f32 v122, v122, v115
    v_add_f32 v123, v123, v119
    ds_write_b32 v157, v120 offset:0
    ds_write_b32 v157, v121 offset:128
    ds_write_b32 v157, v122 offset:256
    ds_write_b32 v157, v123 offset:384
    v_mov_b32 v107, 0
    v_mov_b32 v111, 0
    v_mov_b32 v115, 0
    v_mov_b32 v119, 0
    s_mov_b64 exec, -1
    s_and_b32 vcc_lo, vcc_lo, 0x130033
    s_cbranch_scc0 S_tl_nofl
    s_branch S_tlfl_go
.section .rodata,"a"
.p2align 6
.amdhsa_kernel standalone__edge_featured_mpnn_mpnn__graph_kernel
.amdhsa_next_free_vgpr 256
.amdhsa_next_free_sgpr 102
.amdhsa_accum_offset 176
.amdhsa_group_segment_fixed_size 0
.amdhsa_kernarg_size 88
.amdhsa_user_sgpr_count 2
.amdhsa_user_sgpr_kernarg_segment_ptr 1
.amdhsa_system_sgpr_workgroup_id_x 1
.end_amdhsa_kernel
```
